```python
import torch

def _softmax(x, axis=-1):
    return torch.softmax(x, dim=axis)
def _gelu(x):
    return torch.nn.functional.gelu(x, approximate="tanh")
def _silu(x):
    return torch.nn.functional.silu(x)
def _sigmoid(x):
    return torch.sigmoid(x)
def _layernorm(x, axis=-1, eps=1e-5):
    m = x.mean(dim=axis, keepdim=True)
    v = x.var(dim=axis, keepdim=True, unbiased=False)
    return (x - m) / torch.sqrt(v + eps)
def _scatter_add(tgt, idx, src, axis=0):
    return tgt.clone().index_add_(axis, idx, src)
def _segment_sum(src, seg, n):
    out = torch.zeros((n,) + src.shape[1:], dtype=src.dtype)
    return out.index_add_(0, seg, src)
def _pad(x, pw):
    flat = tuple(v for pair in reversed(pw) for v in pair)
    return torch.nn.functional.pad(x, flat)

kernel_name = 'standalone__low_rank_proj_linformer__decode'

def setup_inputs():

    _w = (lambda a: (lambda t: t.to(torch.bfloat16) if t.is_floating_point() else t)(torch.as_tensor(a)))
    B, H, Sq, Skv, Dh, R = 4, 32, 1, 8192, 128, 64
    return {
        "q": _w((lambda *s: torch.randn(*s, dtype=torch.bfloat16) * 0.8)(B, H, Sq, Dh)),
        "k": _w((lambda *s: torch.randn(*s, dtype=torch.bfloat16) * 0.8)(B, H, Skv, Dh)),
        "v": _w((lambda *s: torch.randn(*s, dtype=torch.bfloat16) * 0.05)(B, H, Skv, Dh)),
        "e_proj": _w((lambda *s: torch.randn(*s, dtype=torch.bfloat16) * 0.8)(R, Skv) * (Skv ** -0.5)),
        "f_proj": _w((lambda *s: torch.randn(*s, dtype=torch.bfloat16) * 0.05)(R, Skv) * (Skv ** -0.5)),
    }

def reference(q, k, v, e_proj, f_proj):
    B, H, Sq, Dh = q.shape
    kp = torch.einsum("rn,bhnd->bhrd", e_proj, k)
    vp = torch.einsum("rn,bhnd->bhrd", f_proj, v)
    scores = torch.einsum("bhqd,bhrd->bhqr", q, kp) * (Dh ** -0.5)
    p = _softmax(scores, axis=-1)
    o = torch.einsum("bhqr,bhrd->bhqd", p, vp)
    return o
```

```asm
; @launch grid=(256,1,1) block=(320,1,1) lds=150080
.amdgcn_target "amdgcn-amd-amdhsa--gfx950"
.text
.globl standalone__low_rank_proj_linformer__decode_kernel
.p2align 8
.type standalone__low_rank_proj_linformer__decode_kernel,@function
standalone__low_rank_proj_linformer__decode_kernel:
    s_cmp_ge_u32 s2, 256
    s_cbranch_scc1 L_end
    s_load_dwordx8 s[4:11], s[0:1], 0
    s_load_dwordx8 s[12:19], s[0:1], 32
    v_lshrrev_b32 v1, 6, v0
    v_and_b32 v0, 63, v0
    v_readfirstlane_b32 s3, v1
    s_and_b32 s32, s2, 15
    s_lshr_b32 s33, s2, 4
    v_and_b32 v16, 15, v0
    v_lshrrev_b32 v17, 4, v0
    v_mov_b32 v6, 150016
    s_and_b32 s34, s33, 14
    s_lshl_b32 s34, s34, 3
    s_and_b32 s54, s33, 1
    s_add_u32 s34, s34, s54
    s_cmp_eq_u32 s3, 4
    s_cbranch_scc1 L_helper
    s_setprio 1
    s_lshl_b32 s54, s3, 1
    s_add_u32 s34, s34, s54
    v_lshlrev_b32 v18, 4, v16
    v_lshlrev_b32 v1, 4, v0
    s_lshl_b32 s29, s3, 12
    s_movk_i32 s80, 4096
    s_lshl_b32 s49, s32, 14
    s_mov_b32 s42, s49
    s_xor_b32 s24, s42, s29
    s_xor_b32 s25, s24, s80
    s_lshl_b32 s54, s34, 21
    s_lshl_b32 s55, s34, 8
    s_mov_b32 s22, 2097152
    s_mov_b32 s23, 0x20000
    s_waitcnt lgkmcnt(0)
    s_add_u32 s20, s6, s54
    s_addc_u32 s21, s7, 0
    s_add_u32 s4, s4, s55
    s_addc_u32 s5, s5, 0
    buffer_load_dwordx4 v[88:91], v1, s[20:23], s24 offen offset:0 nt
    buffer_load_dwordx4 v[92:95], v1, s[20:23], s24 offen offset:1024 nt
    global_load_dwordx4 v[24:27], v18, s[4:5]
    buffer_load_dwordx4 v[96:99], v1, s[20:23], s24 offen offset:2048 nt
    buffer_load_dwordx4 v[100:103], v1, s[20:23], s24 offen offset:3072 nt
    buffer_load_dwordx4 v[104:107], v1, s[20:23], s25 offen offset:0 nt
    global_load_dwordx4 v[28:31], v18, s[4:5] offset:2048
    s_mov_b32 s72, 0x100000
    s_mov_b32 s45, 8192
    s_mov_b32 s40, 0
    s_mov_b32 s36, s20
    s_mov_b32 s37, s21
    s_mov_b32 s38, 2097152
    s_mov_b32 s39, 0x20000
    s_add_u32 s46, s20, 16777216
    s_addc_u32 s47, s21, 0
    s_add_u32 s50, s8, s54
    s_addc_u32 s51, s9, 0
    s_add_u32 s52, s50, 16777216
    s_addc_u32 s53, s51, 0
    v_bfe_u32 v18, v0, 1, 3
    v_xor_b32 v18, v18, v17
    s_lshl_b32 s56, s3, 1
    v_xor_b32 v18, s56, v18
    v_lshlrev_b32 v18, 4, v18
    v_lshl_add_u32 v2, v16, 7, v18
    v_xor_b32 v3, 64, v2
    s_lshl_b32 s56, s3, 8
    s_add_u32 s56, s56, 147456
    v_lshl_add_u32 v18, v16, 4, s56
    v_lshl_add_u32 v7, v17, 6, v18
    v_and_b32 v154, 31, v0
    v_lshlrev_b32 v154, 4, v154
    v_lshrrev_b32 v18, 5, v0
    v_lshl_add_u32 v154, v18, 15, v154
    s_mov_b32 s60, 0xaaaaaaaa
    s_mov_b32 s61, 0xaaaaaaaa
    s_mov_b32 s62, 0xcccccccc
    s_mov_b32 s63, 0xcccccccc
    s_mov_b32 s64, 0xf000f
    s_mov_b32 s65, 0xf000f
    s_lshl_b32 s54, s33, 16
    s_lshl_b32 s55, s3, 13
    s_add_u32 s54, s54, s55
    s_lshl_b32 s55, s32, 9
    s_add_u32 s54, s54, s55
    s_add_u32 s54, s54, 2097152
    s_add_u32 s26, s18, s54
    s_addc_u32 s27, s19, 0
    s_lshl_b32 s54, s3, 2
    s_add_u32 s54, s54, 150032
    v_mov_b32 v152, s54
    s_lshl_b32 s79, s3, 4
    v_mov_b32 v40, 0
    v_mov_b32 v41, 0
    v_mov_b32 v42, 0
    v_mov_b32 v43, 0
    v_mov_b32 v44, 0
    v_mov_b32 v45, 0
    v_mov_b32 v46, 0
    v_mov_b32 v47, 0
    v_mov_b32 v48, 0
    v_mov_b32 v49, 0
    v_mov_b32 v50, 0
    v_mov_b32 v51, 0
    v_mov_b32 v52, 0
    v_mov_b32 v53, 0
    v_mov_b32 v54, 0
    v_mov_b32 v55, 0
    s_mov_b32 s43, 0
    s_mov_b32 s44, 0
    s_mov_b32 s48, 0
    s_mov_b32 s28, 1
    s_waitcnt vmcnt(4)
L_kloop:
    s_add_u32 s55, s42, s45
    s_xor_b32 s66, s55, s29
    s_xor_b32 s67, s66, s80
    s_lshl_b32 s55, s40, 13
    v_add_u32 v4, s55, v2
    v_add_u32 v5, s55, v3
    s_waitcnt vmcnt(4)
    buffer_load_dwordx4 v[108:111], v1, s[20:23], s25 offen offset:1024 nt
    v_dot2_f32_bf16 v156, v88, v24, 0
    v_dot2_f32_bf16 v156, v89, v25, v156
    v_dot2_f32_bf16 v156, v90, v26, v156
    v_dot2_f32_bf16 v156, v91, v27, v156
    s_waitcnt vmcnt(4)
    buffer_load_dwordx4 v[112:115], v1, s[20:23], s25 offen offset:2048 nt
    v_dot2_f32_bf16 v157, v92, v24, 0
    v_dot2_f32_bf16 v157, v93, v25, v157
    v_dot2_f32_bf16 v157, v94, v26, v157
    v_dot2_f32_bf16 v157, v95, v27, v157
    s_waitcnt vmcnt(4)
    buffer_load_dwordx4 v[116:119], v1, s[20:23], s25 offen offset:3072 nt
    v_dot2_f32_bf16 v158, v96, v24, 0
    v_dot2_f32_bf16 v158, v97, v25, v158
    v_dot2_f32_bf16 v158, v98, v26, v158
    v_dot2_f32_bf16 v158, v99, v27, v158
    s_waitcnt vmcnt(4)
    buffer_load_dwordx4 v[120:123], v1, s[36:39], s66 offen offset:0 nt
    v_dot2_f32_bf16 v159, v100, v24, 0
    v_dot2_f32_bf16 v159, v101, v25, v159
    v_dot2_f32_bf16 v159, v102, v26, v159
    v_dot2_f32_bf16 v159, v103, v27, v159
    s_waitcnt vmcnt(4)
    buffer_load_dwordx4 v[124:127], v1, s[36:39], s66 offen offset:1024 nt
    v_dot2_f32_bf16 v160, v104, v24, 0
    v_dot2_f32_bf16 v160, v105, v25, v160
    v_dot2_f32_bf16 v160, v106, v26, v160
    v_dot2_f32_bf16 v160, v107, v27, v160
    s_waitcnt vmcnt(4)
    buffer_load_dwordx4 v[128:131], v1, s[36:39], s66 offen offset:2048 nt
    v_dot2_f32_bf16 v161, v108, v24, 0
    v_dot2_f32_bf16 v161, v109, v25, v161
    v_dot2_f32_bf16 v161, v110, v26, v161
    v_dot2_f32_bf16 v161, v111, v27, v161
    s_waitcnt vmcnt(4)
    buffer_load_dwordx4 v[132:135], v1, s[36:39], s66 offen offset:3072 nt
    v_dot2_f32_bf16 v162, v112, v24, 0
    v_dot2_f32_bf16 v162, v113, v25, v162
    v_dot2_f32_bf16 v162, v114, v26, v162
    v_dot2_f32_bf16 v162, v115, v27, v162
    s_waitcnt vmcnt(4)
    buffer_load_dwordx4 v[136:139], v1, s[36:39], s67 offen offset:0 nt
    v_dot2_f32_bf16 v163, v116, v24, 0
    v_dot2_f32_bf16 v163, v117, v25, v163
    v_dot2_f32_bf16 v163, v118, v26, v163
    v_dot2_f32_bf16 v163, v119, v27, v163
    s_mov_b64 s[20:21], s[36:37]
    s_mov_b64 s[24:25], s[66:67]
    s_waitcnt vmcnt(4)
    buffer_load_dwordx4 v[140:143], v1, s[20:23], s25 offen offset:1024 nt
    v_dot2_f32_bf16 v164, v120, v24, 0
    v_dot2_f32_bf16 v164, v121, v25, v164
    v_dot2_f32_bf16 v164, v122, v26, v164
    v_dot2_f32_bf16 v164, v123, v27, v164
    s_waitcnt vmcnt(4)
    buffer_load_dwordx4 v[144:147], v1, s[20:23], s25 offen offset:2048 nt
    v_dot2_f32_bf16 v165, v124, v24, 0
    v_dot2_f32_bf16 v165, v125, v25, v165
    v_dot2_f32_bf16 v165, v126, v26, v165
    v_dot2_f32_bf16 v165, v127, v27, v165
    s_waitcnt vmcnt(4)
    buffer_load_dwordx4 v[148:151], v1, s[20:23], s25 offen offset:3072 nt
    v_dot2_f32_bf16 v166, v128, v24, 0
    v_dot2_f32_bf16 v166, v129, v25, v166
    v_dot2_f32_bf16 v166, v130, v26, v166
    v_dot2_f32_bf16 v166, v131, v27, v166
    s_cmp_lg_u32 s44, 1
    s_cbranch_scc1 L_kn1
L_w1:
    ds_read_b32 v18, v6 offset:8
    s_waitcnt lgkmcnt(0)
    v_readfirstlane_b32 s54, v18
    s_cmp_ge_u32 s54, 0x80000000
    s_cbranch_scc1 L_w1_ok
    s_sleep 1
    s_sub_u32 s72, s72, 1
    s_cbranch_scc1 L_end
    s_branch L_w1
L_w1_ok:
    s_and_b32 s49, s54, 0x3a000
    s_bfe_u32 s55, s54, 65536
    s_lshl_b32 s55, s55, 13
    s_andn2_b32 s73, s49, 0x2000
    s_or_b32 s73, s73, s55
    s_and_b32 s29, s3, 1
    s_lshl_b32 s29, s29, 12
    s_lshr_b32 s55, s3, 1
    s_lshl_b32 s55, s55, 14
    s_or_b32 s29, s29, s55
    s_mov_b32 s45, 16384
    s_mov_b32 s80, 4096
L_kn1:
    s_add_u32 s41, s40, 1
    s_and_b32 s41, s41, 7
    s_cbranch_scc1 L_kn2
    s_mov_b64 s[36:37], s[46:47]
    s_cmp_eq_u32 s43, 1
    s_cselect_b32 s49, s73, s49
L_kn2:
    s_lshl_b32 s42, s41, 18
    s_add_u32 s42, s42, s49
    s_xor_b32 s66, s42, s29
    s_xor_b32 s67, s66, s80
    s_waitcnt vmcnt(4)
    buffer_load_dwordx4 v[88:91], v1, s[36:39], s66 offen offset:0 nt
    v_dot2_f32_bf16 v167, v132, v24, 0
    v_dot2_f32_bf16 v167, v133, v25, v167
    v_dot2_f32_bf16 v167, v134, v26, v167
    v_dot2_f32_bf16 v167, v135, v27, v167
    s_waitcnt vmcnt(4)
    buffer_load_dwordx4 v[92:95], v1, s[36:39], s66 offen offset:1024 nt
    v_dot2_f32_bf16 v168, v136, v24, 0
    v_dot2_f32_bf16 v168, v137, v25, v168
    v_dot2_f32_bf16 v168, v138, v26, v168
    v_dot2_f32_bf16 v168, v139, v27, v168
    s_waitcnt vmcnt(4)
    buffer_load_dwordx4 v[96:99], v1, s[36:39], s66 offen offset:2048 nt
    v_dot2_f32_bf16 v169, v140, v24, 0
    v_dot2_f32_bf16 v169, v141, v25, v169
    v_dot2_f32_bf16 v169, v142, v26, v169
    v_dot2_f32_bf16 v169, v143, v27, v169
    s_cmp_lg_u32 s44, 0
    s_cbranch_scc1 L_nobar
    s_barrier
L_nobar:
L_w2:
    ds_read_b32 v16, v6 offset:0
    s_waitcnt lgkmcnt(0)
    v_readfirstlane_b32 s54, v16
    s_cmp_ge_u32 s54, s28
    s_cbranch_scc1 L_w2_ok
    s_sleep 1
    s_sub_u32 s72, s72, 1
    s_cbranch_scc1 L_end
    s_branch L_w2
L_w2_ok:
    ds_read_b128 v[56:59], v4 offset:0
    ds_read_b128 v[60:63], v4 offset:2048
    ds_read_b128 v[64:67], v4 offset:4096
    ds_read_b128 v[68:71], v4 offset:6144
    ds_read_b128 v[72:75], v5 offset:0
    ds_read_b128 v[76:79], v5 offset:2048
    ds_read_b128 v[80:83], v5 offset:4096
    ds_read_b128 v[84:87], v5 offset:6144
    s_waitcnt vmcnt(4)
    buffer_load_dwordx4 v[100:103], v1, s[36:39], s66 offen offset:3072 nt
    v_dot2_f32_bf16 v170, v144, v24, 0
    v_dot2_f32_bf16 v170, v145, v25, v170
    v_dot2_f32_bf16 v170, v146, v26, v170
    v_dot2_f32_bf16 v170, v147, v27, v170
    v_permlane32_swap_b32 v156, v160
    v_permlane32_swap_b32 v158, v162
    v_permlane32_swap_b32 v157, v161
    v_permlane32_swap_b32 v159, v163
    s_nop 0
    v_permlane16_swap_b32 v156, v158
    v_permlane16_swap_b32 v160, v162
    v_permlane16_swap_b32 v157, v159
    v_permlane16_swap_b32 v161, v163
    s_nop 0
    v_cvt_pk_bf16_f32 v32, v156, v158
    v_lshlrev_b32 v16, 16, v32
    v_and_b32 v17, 0xffff0000, v32
    v_sub_f32 v16, v156, v16
    v_sub_f32 v17, v158, v17
    v_cvt_pk_bf16_f32 v36, v16, v17
    v_cvt_pk_bf16_f32 v33, v160, v162
    v_lshlrev_b32 v16, 16, v33
    v_and_b32 v17, 0xffff0000, v33
    v_sub_f32 v16, v160, v16
    v_sub_f32 v17, v162, v17
    v_cvt_pk_bf16_f32 v37, v16, v17
    v_cvt_pk_bf16_f32 v34, v157, v159
    v_lshlrev_b32 v16, 16, v34
    v_and_b32 v17, 0xffff0000, v34
    v_sub_f32 v16, v157, v16
    v_sub_f32 v17, v159, v17
    v_cvt_pk_bf16_f32 v38, v16, v17
    v_cvt_pk_bf16_f32 v35, v161, v163
    v_lshlrev_b32 v16, 16, v35
    v_and_b32 v17, 0xffff0000, v35
    v_sub_f32 v16, v161, v16
    v_sub_f32 v17, v163, v17
    v_cvt_pk_bf16_f32 v39, v16, v17
    s_waitcnt lgkmcnt(0)
    s_nop 0
    v_mfma_f32_16x16x32_bf16 v[40:43], v[56:59], v[32:35], v[40:43]
    v_mfma_f32_16x16x32_bf16 v[44:47], v[60:63], v[32:35], v[44:47]
    v_mfma_f32_16x16x32_bf16 v[48:51], v[64:67], v[32:35], v[48:51]
    v_mfma_f32_16x16x32_bf16 v[52:55], v[68:71], v[32:35], v[52:55]
    v_mfma_f32_16x16x32_bf16 v[40:43], v[56:59], v[36:39], v[40:43]
    v_mfma_f32_16x16x32_bf16 v[44:47], v[60:63], v[36:39], v[44:47]
    v_mfma_f32_16x16x32_bf16 v[48:51], v[64:67], v[36:39], v[48:51]
    v_mfma_f32_16x16x32_bf16 v[52:55], v[68:71], v[36:39], v[52:55]
    s_waitcnt vmcnt(4)
    buffer_load_dwordx4 v[104:107], v1, s[36:39], s67 offen offset:0 nt
    v_dot2_f32_bf16 v171, v148, v24, 0
    v_dot2_f32_bf16 v171, v149, v25, v171
    v_dot2_f32_bf16 v171, v150, v26, v171
    v_dot2_f32_bf16 v171, v151, v27, v171
    s_nop 3
    v_permlane32_swap_b32 v164, v168
    v_permlane32_swap_b32 v166, v170
    v_permlane32_swap_b32 v165, v169
    v_permlane32_swap_b32 v167, v171
    s_nop 0
    v_permlane16_swap_b32 v164, v166
    v_permlane16_swap_b32 v168, v170
    v_permlane16_swap_b32 v165, v167
    v_permlane16_swap_b32 v169, v171
    s_nop 0
    v_cvt_pk_bf16_f32 v32, v164, v166
    v_lshlrev_b32 v16, 16, v32
    v_and_b32 v17, 0xffff0000, v32
    v_sub_f32 v16, v164, v16
    v_sub_f32 v17, v166, v17
    v_cvt_pk_bf16_f32 v36, v16, v17
    v_cvt_pk_bf16_f32 v33, v168, v170
    v_lshlrev_b32 v16, 16, v33
    v_and_b32 v17, 0xffff0000, v33
    v_sub_f32 v16, v168, v16
    v_sub_f32 v17, v170, v17
    v_cvt_pk_bf16_f32 v37, v16, v17
    v_cvt_pk_bf16_f32 v34, v165, v167
    v_lshlrev_b32 v16, 16, v34
    v_and_b32 v17, 0xffff0000, v34
    v_sub_f32 v16, v165, v16
    v_sub_f32 v17, v167, v17
    v_cvt_pk_bf16_f32 v38, v16, v17
    v_cvt_pk_bf16_f32 v35, v169, v171
    v_lshlrev_b32 v16, 16, v35
    v_and_b32 v17, 0xffff0000, v35
    v_sub_f32 v16, v169, v16
    v_sub_f32 v17, v171, v17
    v_cvt_pk_bf16_f32 v39, v16, v17
    s_waitcnt lgkmcnt(0)
    s_nop 0
    v_mfma_f32_16x16x32_bf16 v[40:43], v[72:75], v[32:35], v[40:43]
    v_mfma_f32_16x16x32_bf16 v[44:47], v[76:79], v[32:35], v[44:47]
    v_mfma_f32_16x16x32_bf16 v[48:51], v[80:83], v[32:35], v[48:51]
    v_mfma_f32_16x16x32_bf16 v[52:55], v[84:87], v[32:35], v[52:55]
    v_mfma_f32_16x16x32_bf16 v[40:43], v[72:75], v[36:39], v[40:43]
    v_mfma_f32_16x16x32_bf16 v[44:47], v[76:79], v[36:39], v[44:47]
    v_mfma_f32_16x16x32_bf16 v[48:51], v[80:83], v[36:39], v[48:51]
    v_mfma_f32_16x16x32_bf16 v[52:55], v[84:87], v[36:39], v[52:55]
    s_mov_b64 s[20:21], s[36:37]
    s_mov_b64 s[24:25], s[66:67]
    s_cmp_lg_u32 s44, 1
    s_cbranch_scc1 L_nopre
    global_load_dwordx4 v[172:175], v154, s[26:27] sc1
L_nopre:
    s_add_u32 s44, s44, 1
    s_lshl_b32 s55, s44, 2
    v_mov_b32 v16, s55
    ds_write_b32 v152, v16
    s_add_u32 s28, s28, 1
    s_min_u32 s28, s28, 10
    s_mov_b32 s40, s41
    s_cmp_lg_u32 s40, 0
    s_cbranch_scc1 L_kloop
    s_nop 4
    v_add_f32_dpp v40, v40, v40 row_ror:8 row_mask:0xf bank_mask:0xf
    v_add_f32_dpp v41, v41, v41 row_ror:8 row_mask:0xf bank_mask:0xf
    v_add_f32_dpp v42, v42, v42 row_ror:8 row_mask:0xf bank_mask:0xf
    v_add_f32_dpp v43, v43, v43 row_ror:8 row_mask:0xf bank_mask:0xf
    v_add_f32_dpp v44, v44, v44 row_ror:8 row_mask:0xf bank_mask:0xf
    v_add_f32_dpp v45, v45, v45 row_ror:8 row_mask:0xf bank_mask:0xf
    v_add_f32_dpp v46, v46, v46 row_ror:8 row_mask:0xf bank_mask:0xf
    v_add_f32_dpp v47, v47, v47 row_ror:8 row_mask:0xf bank_mask:0xf
    v_add_f32_dpp v48, v48, v48 row_ror:8 row_mask:0xf bank_mask:0xf
    v_add_f32_dpp v49, v49, v49 row_ror:8 row_mask:0xf bank_mask:0xf
    v_add_f32_dpp v50, v50, v50 row_ror:8 row_mask:0xf bank_mask:0xf
    v_add_f32_dpp v51, v51, v51 row_ror:8 row_mask:0xf bank_mask:0xf
    v_add_f32_dpp v52, v52, v52 row_ror:8 row_mask:0xf bank_mask:0xf
    v_add_f32_dpp v53, v53, v53 row_ror:8 row_mask:0xf bank_mask:0xf
    v_add_f32_dpp v54, v54, v54 row_ror:8 row_mask:0xf bank_mask:0xf
    v_add_f32_dpp v55, v55, v55 row_ror:8 row_mask:0xf bank_mask:0xf
    v_add_f32_dpp v40, v40, v40 row_ror:4 row_mask:0xf bank_mask:0xf
    v_add_f32_dpp v41, v41, v41 row_ror:4 row_mask:0xf bank_mask:0xf
    v_add_f32_dpp v42, v42, v42 row_ror:4 row_mask:0xf bank_mask:0xf
    v_add_f32_dpp v43, v43, v43 row_ror:4 row_mask:0xf bank_mask:0xf
    v_add_f32_dpp v44, v44, v44 row_ror:4 row_mask:0xf bank_mask:0xf
    v_add_f32_dpp v45, v45, v45 row_ror:4 row_mask:0xf bank_mask:0xf
    v_add_f32_dpp v46, v46, v46 row_ror:4 row_mask:0xf bank_mask:0xf
    v_add_f32_dpp v47, v47, v47 row_ror:4 row_mask:0xf bank_mask:0xf
    v_add_f32_dpp v48, v48, v48 row_ror:4 row_mask:0xf bank_mask:0xf
    v_add_f32_dpp v49, v49, v49 row_ror:4 row_mask:0xf bank_mask:0xf
    v_add_f32_dpp v50, v50, v50 row_ror:4 row_mask:0xf bank_mask:0xf
    v_add_f32_dpp v51, v51, v51 row_ror:4 row_mask:0xf bank_mask:0xf
    v_add_f32_dpp v52, v52, v52 row_ror:4 row_mask:0xf bank_mask:0xf
    v_add_f32_dpp v53, v53, v53 row_ror:4 row_mask:0xf bank_mask:0xf
    v_add_f32_dpp v54, v54, v54 row_ror:4 row_mask:0xf bank_mask:0xf
    v_add_f32_dpp v55, v55, v55 row_ror:4 row_mask:0xf bank_mask:0xf
    v_add_f32_dpp v40, v40, v40 row_ror:2 row_mask:0xf bank_mask:0xf
    v_add_f32_dpp v41, v41, v41 row_ror:2 row_mask:0xf bank_mask:0xf
    v_add_f32_dpp v42, v42, v42 row_ror:2 row_mask:0xf bank_mask:0xf
    v_add_f32_dpp v43, v43, v43 row_ror:2 row_mask:0xf bank_mask:0xf
    v_add_f32_dpp v44, v44, v44 row_ror:2 row_mask:0xf bank_mask:0xf
    v_add_f32_dpp v45, v45, v45 row_ror:2 row_mask:0xf bank_mask:0xf
    v_add_f32_dpp v46, v46, v46 row_ror:2 row_mask:0xf bank_mask:0xf
    v_add_f32_dpp v47, v47, v47 row_ror:2 row_mask:0xf bank_mask:0xf
    v_add_f32_dpp v48, v48, v48 row_ror:2 row_mask:0xf bank_mask:0xf
    v_add_f32_dpp v49, v49, v49 row_ror:2 row_mask:0xf bank_mask:0xf
    v_add_f32_dpp v50, v50, v50 row_ror:2 row_mask:0xf bank_mask:0xf
    v_add_f32_dpp v51, v51, v51 row_ror:2 row_mask:0xf bank_mask:0xf
    v_add_f32_dpp v52, v52, v52 row_ror:2 row_mask:0xf bank_mask:0xf
    v_add_f32_dpp v53, v53, v53 row_ror:2 row_mask:0xf bank_mask:0xf
    v_add_f32_dpp v54, v54, v54 row_ror:2 row_mask:0xf bank_mask:0xf
    v_add_f32_dpp v55, v55, v55 row_ror:2 row_mask:0xf bank_mask:0xf
    v_add_f32_dpp v40, v40, v40 row_ror:1 row_mask:0xf bank_mask:0xf
    v_add_f32_dpp v41, v41, v41 row_ror:1 row_mask:0xf bank_mask:0xf
    v_add_f32_dpp v42, v42, v42 row_ror:1 row_mask:0xf bank_mask:0xf
    v_add_f32_dpp v43, v43, v43 row_ror:1 row_mask:0xf bank_mask:0xf
    v_add_f32_dpp v44, v44, v44 row_ror:1 row_mask:0xf bank_mask:0xf
    v_add_f32_dpp v45, v45, v45 row_ror:1 row_mask:0xf bank_mask:0xf
    v_add_f32_dpp v46, v46, v46 row_ror:1 row_mask:0xf bank_mask:0xf
    v_add_f32_dpp v47, v47, v47 row_ror:1 row_mask:0xf bank_mask:0xf
    v_add_f32_dpp v48, v48, v48 row_ror:1 row_mask:0xf bank_mask:0xf
    v_add_f32_dpp v49, v49, v49 row_ror:1 row_mask:0xf bank_mask:0xf
    v_add_f32_dpp v50, v50, v50 row_ror:1 row_mask:0xf bank_mask:0xf
    v_add_f32_dpp v51, v51, v51 row_ror:1 row_mask:0xf bank_mask:0xf
    v_add_f32_dpp v52, v52, v52 row_ror:1 row_mask:0xf bank_mask:0xf
    v_add_f32_dpp v53, v53, v53 row_ror:1 row_mask:0xf bank_mask:0xf
    v_add_f32_dpp v54, v54, v54 row_ror:1 row_mask:0xf bank_mask:0xf
    v_add_f32_dpp v55, v55, v55 row_ror:1 row_mask:0xf bank_mask:0xf
    v_cndmask_b32 v40, v40, v44, s[60:61]
    v_cndmask_b32 v48, v48, v52, s[60:61]
    v_cndmask_b32 v41, v41, v45, s[60:61]
    v_cndmask_b32 v49, v49, v53, s[60:61]
    v_cndmask_b32 v42, v42, v46, s[60:61]
    v_cndmask_b32 v50, v50, v54, s[60:61]
    v_cndmask_b32 v43, v43, v47, s[60:61]
    v_cndmask_b32 v51, v51, v55, s[60:61]
    v_cndmask_b32 v16, v40, v48, s[62:63]
    v_cndmask_b32 v17, v41, v49, s[62:63]
    v_cndmask_b32 v18, v42, v50, s[62:63]
    v_cndmask_b32 v19, v43, v51, s[62:63]
    s_mov_b64 exec, s[64:65]
    ds_write_b128 v7, v[16:19]
    s_mov_b64 exec, -1
    v_mov_b32 v40, 0
    v_mov_b32 v41, 0
    v_mov_b32 v42, 0
    v_mov_b32 v43, 0
    v_mov_b32 v44, 0
    v_mov_b32 v45, 0
    v_mov_b32 v46, 0
    v_mov_b32 v47, 0
    v_mov_b32 v48, 0
    v_mov_b32 v49, 0
    v_mov_b32 v50, 0
    v_mov_b32 v51, 0
    v_mov_b32 v52, 0
    v_mov_b32 v53, 0
    v_mov_b32 v54, 0
    v_mov_b32 v55, 0
    v_mov_b32 v24, v28
    v_mov_b32 v25, v29
    v_mov_b32 v26, v30
    v_mov_b32 v27, v31
    v_add_u32 v7, 1024, v7
    s_mov_b64 s[46:47], s[50:51]
    s_waitcnt lgkmcnt(0)
    s_lshl_b32 s55, s44, 2
    s_add_u32 s55, s55, 1
    v_mov_b32 v20, s55
    ds_write_b32 v152, v20
    s_add_u32 s43, s43, 1
    s_cmp_lt_u32 s43, 2
    s_cbranch_scc1 L_kloop
    s_lshl_b32 s54, s3, 8
    s_add_u32 s54, s54, 131072
    v_lshrrev_b32 v21, 4, v0
    v_lshl_add_u32 v4, v21, 6, s54
    v_subrev_u32 v3, 122880, v4
    v_mov_b32 v8, 0
    v_mov_b32 v9, 0
    v_mov_b32 v10, 0
    v_mov_b32 v11, 0
    v_mov_b32 v12, 0
    v_mov_b32 v13, 0
    v_mov_b32 v14, 0
    v_mov_b32 v15, 0
    v_not_b32 v172, v172
    v_not_b32 v173, v173
    v_not_b32 v174, v174
    v_not_b32 v175, v175
L_w3:
    ds_read_b32 v36, v6 offset:4
    s_waitcnt lgkmcnt(0)
    v_readfirstlane_b32 s54, v36
    s_cmp_ge_u32 s54, 1
    s_cbranch_scc1 L_w3_ok
    s_sleep 1
    s_sub_u32 s72, s72, 1
    s_cbranch_scc1 L_end
    s_branch L_w3
L_w3_ok:
    s_mov_b32 s35, 64
    s_mov_b32 s30, 1
L_vloop:
    v_xor_b32 v38, s79, v4
    v_xor_b32 v39, 16, v38
    ds_read_b128 v[40:43], v38
    ds_read_b128 v[44:47], v39
    s_waitcnt vmcnt(4)
    buffer_load_dwordx4 v[108:111], v1, s[20:23], s25 offen offset:1024 nt
    v_lshlrev_b32 v16, 16, v88
    v_and_b32 v17, 0xffff0000, v88
    v_lshlrev_b32 v18, 16, v89
    v_and_b32 v19, 0xffff0000, v89
    v_lshlrev_b32 v20, 16, v90
    v_and_b32 v21, 0xffff0000, v90
    v_lshlrev_b32 v22, 16, v91
    v_and_b32 v23, 0xffff0000, v91
    s_waitcnt lgkmcnt(0)
    v_fmac_f32 v8, v40, v16
    v_fmac_f32 v9, v40, v17
    v_fmac_f32 v10, v40, v18
    v_fmac_f32 v11, v40, v19
    v_fmac_f32 v12, v40, v20
    v_fmac_f32 v13, v40, v21
    v_fmac_f32 v14, v40, v22
    v_fmac_f32 v15, v40, v23
    s_waitcnt vmcnt(4)
    buffer_load_dwordx4 v[112:115], v1, s[20:23], s25 offen offset:2048 nt
    v_lshlrev_b32 v16, 16, v92
    v_and_b32 v17, 0xffff0000, v92
    v_lshlrev_b32 v18, 16, v93
    v_and_b32 v19, 0xffff0000, v93
    v_lshlrev_b32 v20, 16, v94
    v_and_b32 v21, 0xffff0000, v94
    v_lshlrev_b32 v22, 16, v95
    v_and_b32 v23, 0xffff0000, v95
    v_fmac_f32 v8, v41, v16
    v_fmac_f32 v9, v41, v17
    v_fmac_f32 v10, v41, v18
    v_fmac_f32 v11, v41, v19
    v_fmac_f32 v12, v41, v20
    v_fmac_f32 v13, v41, v21
    v_fmac_f32 v14, v41, v22
    v_fmac_f32 v15, v41, v23
    s_waitcnt vmcnt(4)
    buffer_load_dwordx4 v[116:119], v1, s[20:23], s25 offen offset:3072 nt
    v_lshlrev_b32 v16, 16, v96
    v_and_b32 v17, 0xffff0000, v96
    v_lshlrev_b32 v18, 16, v97
    v_and_b32 v19, 0xffff0000, v97
    v_lshlrev_b32 v20, 16, v98
    v_and_b32 v21, 0xffff0000, v98
    v_lshlrev_b32 v22, 16, v99
    v_and_b32 v23, 0xffff0000, v99
    v_fmac_f32 v8, v42, v16
    v_fmac_f32 v9, v42, v17
    v_fmac_f32 v10, v42, v18
    v_fmac_f32 v11, v42, v19
    v_fmac_f32 v12, v42, v20
    v_fmac_f32 v13, v42, v21
    v_fmac_f32 v14, v42, v22
    v_fmac_f32 v15, v42, v23
    s_cmp_eq_u32 s30, 0
    s_cbranch_scc1 L_vi0
    s_add_u32 s42, s42, 16384
    v_add_u32 v4, 32, v4
    s_mov_b32 s30, 0
    s_mov_b32 s31, 0
    s_branch L_vgo0
L_vi0:
    s_add_u32 s44, s44, 1
    s_cmp_ge_u32 s44, 30
    s_cbranch_scc1 L_vmb0
    s_mov_b32 s31, 0
    s_and_b32 s41, s44, 7
    s_cbranch_scc1 L_ndv0
    s_mov_b64 s[36:37], s[52:53]
    s_mov_b32 s31, 2
L_ndv0:
    s_lshl_b32 s42, s41, 18
    s_add_u32 s42, s42, s73
    v_add_u32 v4, 992, v4
    s_mov_b32 s30, 1
    s_branch L_vgo0
L_vmb0:
    s_and_b32 s55, s44, 3
    s_lshl_b32 s56, s55, 2
    v_add_u32 v5, s56, v6
L_w4:
    ds_read_b32 v36, v5 offset:32
    s_waitcnt lgkmcnt(0)
    v_readfirstlane_b32 s42, v36
    s_lshr_b32 s54, s42, 16
    s_cmp_eq_u32 s54, s44
    s_cbranch_scc1 L_w4_ok
    s_sleep 1
    s_sub_u32 s72, s72, 1
    s_cbranch_scc1 L_end
    s_branch L_w4
L_w4_ok:
    s_bfe_u32 s55, s42, 262156
    s_lshl_b32 s55, s55, 10
    s_bfe_u32 s30, s42, 65546
    s_bfe_u32 s56, s42, 65545
    s_bitcmp1_b32 s42, 11
    s_cselect_b32 s38, 0, s38
    s_cselect_b32 s48, 1, 0
    s_and_b32 s42, s42, 0x1ff
    s_lshl_b32 s42, s42, 12
    s_lshl_b32 s57, s56, 14
    s_add_u32 s42, s42, s57
    s_lshl_b32 s56, s56, 5
    s_add_u32 s55, s55, s56
    v_add_u32 v4, s55, v3
    s_mov_b32 s31, 3
L_vgo0:
    s_xor_b32 s66, s42, s29
    s_xor_b32 s67, s66, s80
    s_waitcnt vmcnt(4)
    buffer_load_dwordx4 v[120:123], v1, s[36:39], s66 offen offset:0 nt
    v_lshlrev_b32 v16, 16, v100
    v_and_b32 v17, 0xffff0000, v100
    v_lshlrev_b32 v18, 16, v101
    v_and_b32 v19, 0xffff0000, v101
    v_lshlrev_b32 v20, 16, v102
    v_and_b32 v21, 0xffff0000, v102
    v_lshlrev_b32 v22, 16, v103
    v_and_b32 v23, 0xffff0000, v103
    v_fmac_f32 v8, v43, v16
    v_fmac_f32 v9, v43, v17
    v_fmac_f32 v10, v43, v18
    v_fmac_f32 v11, v43, v19
    v_fmac_f32 v12, v43, v20
    v_fmac_f32 v13, v43, v21
    v_fmac_f32 v14, v43, v22
    v_fmac_f32 v15, v43, v23
    s_add_u32 s35, s35, 1
    v_mov_b32 v37, s35
    ds_write_b32 v152, v37
    s_waitcnt vmcnt(4)
    buffer_load_dwordx4 v[124:127], v1, s[36:39], s66 offen offset:1024 nt
    v_lshlrev_b32 v16, 16, v104
    v_and_b32 v17, 0xffff0000, v104
    v_lshlrev_b32 v18, 16, v105
    v_and_b32 v19, 0xffff0000, v105
    v_lshlrev_b32 v20, 16, v106
    v_and_b32 v21, 0xffff0000, v106
    v_lshlrev_b32 v22, 16, v107
    v_and_b32 v23, 0xffff0000, v107
    v_fmac_f32 v8, v44, v16
    v_fmac_f32 v9, v44, v17
    v_fmac_f32 v10, v44, v18
    v_fmac_f32 v11, v44, v19
    v_fmac_f32 v12, v44, v20
    v_fmac_f32 v13, v44, v21
    v_fmac_f32 v14, v44, v22
    v_fmac_f32 v15, v44, v23
    s_waitcnt vmcnt(4)
    buffer_load_dwordx4 v[128:131], v1, s[36:39], s66 offen offset:2048 nt
    v_lshlrev_b32 v16, 16, v108
    v_and_b32 v17, 0xffff0000, v108
    v_lshlrev_b32 v18, 16, v109
    v_and_b32 v19, 0xffff0000, v109
    v_lshlrev_b32 v20, 16, v110
    v_and_b32 v21, 0xffff0000, v110
    v_lshlrev_b32 v22, 16, v111
    v_and_b32 v23, 0xffff0000, v111
    v_fmac_f32 v8, v45, v16
    v_fmac_f32 v9, v45, v17
    v_fmac_f32 v10, v45, v18
    v_fmac_f32 v11, v45, v19
    v_fmac_f32 v12, v45, v20
    v_fmac_f32 v13, v45, v21
    v_fmac_f32 v14, v45, v22
    v_fmac_f32 v15, v45, v23
    s_waitcnt vmcnt(4)
    buffer_load_dwordx4 v[132:135], v1, s[36:39], s66 offen offset:3072 nt
    v_lshlrev_b32 v16, 16, v112
    v_and_b32 v17, 0xffff0000, v112
    v_lshlrev_b32 v18, 16, v113
    v_and_b32 v19, 0xffff0000, v113
    v_lshlrev_b32 v20, 16, v114
    v_and_b32 v21, 0xffff0000, v114
    v_lshlrev_b32 v22, 16, v115
    v_and_b32 v23, 0xffff0000, v115
    v_fmac_f32 v8, v46, v16
    v_fmac_f32 v9, v46, v17
    v_fmac_f32 v10, v46, v18
    v_fmac_f32 v11, v46, v19
    v_fmac_f32 v12, v46, v20
    v_fmac_f32 v13, v46, v21
    v_fmac_f32 v14, v46, v22
    v_fmac_f32 v15, v46, v23
    s_waitcnt vmcnt(4)
    buffer_load_dwordx4 v[136:139], v1, s[36:39], s67 offen offset:0 nt
    v_lshlrev_b32 v16, 16, v116
    v_and_b32 v17, 0xffff0000, v116
    v_lshlrev_b32 v18, 16, v117
    v_and_b32 v19, 0xffff0000, v117
    v_lshlrev_b32 v20, 16, v118
    v_and_b32 v21, 0xffff0000, v118
    v_lshlrev_b32 v22, 16, v119
    v_and_b32 v23, 0xffff0000, v119
    v_fmac_f32 v8, v47, v16
    v_fmac_f32 v9, v47, v17
    v_fmac_f32 v10, v47, v18
    v_fmac_f32 v11, v47, v19
    v_fmac_f32 v12, v47, v20
    v_fmac_f32 v13, v47, v21
    v_fmac_f32 v14, v47, v22
    v_fmac_f32 v15, v47, v23
    s_add_u32 s35, s35, 1
    v_mov_b32 v37, s35
    ds_write_b32 v152, v37
    s_cmp_lg_u32 s48, 0
    s_cbranch_scc1 L_vdone
    s_mov_b64 s[20:21], s[36:37]
    s_mov_b64 s[24:25], s[66:67]
    s_cmp_eq_u32 s31, 0
    s_cbranch_scc1 L_vn0
    s_cmp_lg_u32 s31, 2
    s_cbranch_scc1 L_vna0
    v_mov_b32 v24, v8
    v_mov_b32 v8, 0
    v_mov_b32 v25, v9
    v_mov_b32 v9, 0
    v_mov_b32 v26, v10
    v_mov_b32 v10, 0
    v_mov_b32 v27, v11
    v_mov_b32 v11, 0
    v_mov_b32 v28, v12
    v_mov_b32 v12, 0
    v_mov_b32 v29, v13
    v_mov_b32 v13, 0
    v_mov_b32 v30, v14
    v_mov_b32 v14, 0
    v_mov_b32 v31, v15
    v_mov_b32 v15, 0
L_vna0:
L_w5:
    ds_read_b32 v36, v6 offset:4
    s_waitcnt lgkmcnt(0)
    v_readfirstlane_b32 s54, v36
    s_cmp_ge_u32 s54, s31
    s_cbranch_scc1 L_w5_ok
    s_sleep 1
    s_sub_u32 s72, s72, 1
    s_cbranch_scc1 L_end
    s_branch L_w5
L_w5_ok:
L_vn0:
    v_xor_b32 v38, s79, v4
    v_xor_b32 v39, 16, v38
    ds_read_b128 v[48:51], v38
    ds_read_b128 v[52:55], v39
    s_waitcnt vmcnt(4)
    buffer_load_dwordx4 v[140:143], v1, s[20:23], s25 offen offset:1024 nt
    v_lshlrev_b32 v16, 16, v120
    v_and_b32 v17, 0xffff0000, v120
    v_lshlrev_b32 v18, 16, v121
    v_and_b32 v19, 0xffff0000, v121
    v_lshlrev_b32 v20, 16, v122
    v_and_b32 v21, 0xffff0000, v122
    v_lshlrev_b32 v22, 16, v123
    v_and_b32 v23, 0xffff0000, v123
    s_waitcnt lgkmcnt(0)
    v_fmac_f32 v8, v48, v16
    v_fmac_f32 v9, v48, v17
    v_fmac_f32 v10, v48, v18
    v_fmac_f32 v11, v48, v19
    v_fmac_f32 v12, v48, v20
    v_fmac_f32 v13, v48, v21
    v_fmac_f32 v14, v48, v22
    v_fmac_f32 v15, v48, v23
    s_waitcnt vmcnt(4)
    buffer_load_dwordx4 v[144:147], v1, s[20:23], s25 offen offset:2048 nt
    v_lshlrev_b32 v16, 16, v124
    v_and_b32 v17, 0xffff0000, v124
    v_lshlrev_b32 v18, 16, v125
    v_and_b32 v19, 0xffff0000, v125
    v_lshlrev_b32 v20, 16, v126
    v_and_b32 v21, 0xffff0000, v126
    v_lshlrev_b32 v22, 16, v127
    v_and_b32 v23, 0xffff0000, v127
    v_fmac_f32 v8, v49, v16
    v_fmac_f32 v9, v49, v17
    v_fmac_f32 v10, v49, v18
    v_fmac_f32 v11, v49, v19
    v_fmac_f32 v12, v49, v20
    v_fmac_f32 v13, v49, v21
    v_fmac_f32 v14, v49, v22
    v_fmac_f32 v15, v49, v23
    s_waitcnt vmcnt(4)
    buffer_load_dwordx4 v[148:151], v1, s[20:23], s25 offen offset:3072 nt
    v_lshlrev_b32 v16, 16, v128
    v_and_b32 v17, 0xffff0000, v128
    v_lshlrev_b32 v18, 16, v129
    v_and_b32 v19, 0xffff0000, v129
    v_lshlrev_b32 v20, 16, v130
    v_and_b32 v21, 0xffff0000, v130
    v_lshlrev_b32 v22, 16, v131
    v_and_b32 v23, 0xffff0000, v131
    v_fmac_f32 v8, v50, v16
    v_fmac_f32 v9, v50, v17
    v_fmac_f32 v10, v50, v18
    v_fmac_f32 v11, v50, v19
    v_fmac_f32 v12, v50, v20
    v_fmac_f32 v13, v50, v21
    v_fmac_f32 v14, v50, v22
    v_fmac_f32 v15, v50, v23
    s_cmp_eq_u32 s30, 0
    s_cbranch_scc1 L_vi1
    s_add_u32 s42, s42, 16384
    v_add_u32 v4, 32, v4
    s_mov_b32 s30, 0
    s_mov_b32 s31, 0
    s_branch L_vgo1
L_vi1:
    s_add_u32 s44, s44, 1
    s_cmp_ge_u32 s44, 30
    s_cbranch_scc1 L_vmb1
    s_mov_b32 s31, 0
    s_and_b32 s41, s44, 7
    s_cbranch_scc1 L_ndv1
    s_mov_b64 s[36:37], s[52:53]
    s_mov_b32 s31, 2
L_ndv1:
    s_lshl_b32 s42, s41, 18
    s_add_u32 s42, s42, s73
    v_add_u32 v4, 992, v4
    s_mov_b32 s30, 1
    s_branch L_vgo1
L_vmb1:
    s_and_b32 s55, s44, 3
    s_lshl_b32 s56, s55, 2
    v_add_u32 v5, s56, v6
L_w6:
    ds_read_b32 v36, v5 offset:32
    s_waitcnt lgkmcnt(0)
    v_readfirstlane_b32 s42, v36
    s_lshr_b32 s54, s42, 16
    s_cmp_eq_u32 s54, s44
    s_cbranch_scc1 L_w6_ok
    s_sleep 1
    s_sub_u32 s72, s72, 1
    s_cbranch_scc1 L_end
    s_branch L_w6
L_w6_ok:
    s_bfe_u32 s55, s42, 262156
    s_lshl_b32 s55, s55, 10
    s_bfe_u32 s30, s42, 65546
    s_bfe_u32 s56, s42, 65545
    s_bitcmp1_b32 s42, 11
    s_cselect_b32 s38, 0, s38
    s_cselect_b32 s48, 1, 0
    s_and_b32 s42, s42, 0x1ff
    s_lshl_b32 s42, s42, 12
    s_lshl_b32 s57, s56, 14
    s_add_u32 s42, s42, s57
    s_lshl_b32 s56, s56, 5
    s_add_u32 s55, s55, s56
    v_add_u32 v4, s55, v3
    s_mov_b32 s31, 3
L_vgo1:
    s_xor_b32 s66, s42, s29
    s_xor_b32 s67, s66, s80
    s_waitcnt vmcnt(4)
    buffer_load_dwordx4 v[88:91], v1, s[36:39], s66 offen offset:0 nt
    v_lshlrev_b32 v16, 16, v132
    v_and_b32 v17, 0xffff0000, v132
    v_lshlrev_b32 v18, 16, v133
    v_and_b32 v19, 0xffff0000, v133
    v_lshlrev_b32 v20, 16, v134
    v_and_b32 v21, 0xffff0000, v134
    v_lshlrev_b32 v22, 16, v135
    v_and_b32 v23, 0xffff0000, v135
    v_fmac_f32 v8, v51, v16
    v_fmac_f32 v9, v51, v17
    v_fmac_f32 v10, v51, v18
    v_fmac_f32 v11, v51, v19
    v_fmac_f32 v12, v51, v20
    v_fmac_f32 v13, v51, v21
    v_fmac_f32 v14, v51, v22
    v_fmac_f32 v15, v51, v23
    s_add_u32 s35, s35, 1
    v_mov_b32 v37, s35
    ds_write_b32 v152, v37
    s_waitcnt vmcnt(4)
    buffer_load_dwordx4 v[92:95], v1, s[36:39], s66 offen offset:1024 nt
    v_lshlrev_b32 v16, 16, v136
    v_and_b32 v17, 0xffff0000, v136
    v_lshlrev_b32 v18, 16, v137
    v_and_b32 v19, 0xffff0000, v137
    v_lshlrev_b32 v20, 16, v138
    v_and_b32 v21, 0xffff0000, v138
    v_lshlrev_b32 v22, 16, v139
    v_and_b32 v23, 0xffff0000, v139
    v_fmac_f32 v8, v52, v16
    v_fmac_f32 v9, v52, v17
    v_fmac_f32 v10, v52, v18
    v_fmac_f32 v11, v52, v19
    v_fmac_f32 v12, v52, v20
    v_fmac_f32 v13, v52, v21
    v_fmac_f32 v14, v52, v22
    v_fmac_f32 v15, v52, v23
    s_waitcnt vmcnt(4)
    buffer_load_dwordx4 v[96:99], v1, s[36:39], s66 offen offset:2048 nt
    v_lshlrev_b32 v16, 16, v140
    v_and_b32 v17, 0xffff0000, v140
    v_lshlrev_b32 v18, 16, v141
    v_and_b32 v19, 0xffff0000, v141
    v_lshlrev_b32 v20, 16, v142
    v_and_b32 v21, 0xffff0000, v142
    v_lshlrev_b32 v22, 16, v143
    v_and_b32 v23, 0xffff0000, v143
    v_fmac_f32 v8, v53, v16
    v_fmac_f32 v9, v53, v17
    v_fmac_f32 v10, v53, v18
    v_fmac_f32 v11, v53, v19
    v_fmac_f32 v12, v53, v20
    v_fmac_f32 v13, v53, v21
    v_fmac_f32 v14, v53, v22
    v_fmac_f32 v15, v53, v23
    s_waitcnt vmcnt(4)
    buffer_load_dwordx4 v[100:103], v1, s[36:39], s66 offen offset:3072 nt
    v_lshlrev_b32 v16, 16, v144
    v_and_b32 v17, 0xffff0000, v144
    v_lshlrev_b32 v18, 16, v145
    v_and_b32 v19, 0xffff0000, v145
    v_lshlrev_b32 v20, 16, v146
    v_and_b32 v21, 0xffff0000, v146
    v_lshlrev_b32 v22, 16, v147
    v_and_b32 v23, 0xffff0000, v147
    v_fmac_f32 v8, v54, v16
    v_fmac_f32 v9, v54, v17
    v_fmac_f32 v10, v54, v18
    v_fmac_f32 v11, v54, v19
    v_fmac_f32 v12, v54, v20
    v_fmac_f32 v13, v54, v21
    v_fmac_f32 v14, v54, v22
    v_fmac_f32 v15, v54, v23
    s_waitcnt vmcnt(4)
    buffer_load_dwordx4 v[104:107], v1, s[36:39], s67 offen offset:0 nt
    v_lshlrev_b32 v16, 16, v148
    v_and_b32 v17, 0xffff0000, v148
    v_lshlrev_b32 v18, 16, v149
    v_and_b32 v19, 0xffff0000, v149
    v_lshlrev_b32 v20, 16, v150
    v_and_b32 v21, 0xffff0000, v150
    v_lshlrev_b32 v22, 16, v151
    v_and_b32 v23, 0xffff0000, v151
    v_fmac_f32 v8, v55, v16
    v_fmac_f32 v9, v55, v17
    v_fmac_f32 v10, v55, v18
    v_fmac_f32 v11, v55, v19
    v_fmac_f32 v12, v55, v20
    v_fmac_f32 v13, v55, v21
    v_fmac_f32 v14, v55, v22
    v_fmac_f32 v15, v55, v23
    s_add_u32 s35, s35, 1
    v_mov_b32 v37, s35
    ds_write_b32 v152, v37
    s_cmp_lg_u32 s48, 0
    s_cbranch_scc1 L_vdone
    s_mov_b64 s[20:21], s[36:37]
    s_mov_b64 s[24:25], s[66:67]
    s_cmp_eq_u32 s31, 0
    s_cbranch_scc1 L_vn1
    s_cmp_lg_u32 s31, 2
    s_cbranch_scc1 L_vna1
    v_mov_b32 v24, v8
    v_mov_b32 v8, 0
    v_mov_b32 v25, v9
    v_mov_b32 v9, 0
    v_mov_b32 v26, v10
    v_mov_b32 v10, 0
    v_mov_b32 v27, v11
    v_mov_b32 v11, 0
    v_mov_b32 v28, v12
    v_mov_b32 v12, 0
    v_mov_b32 v29, v13
    v_mov_b32 v13, 0
    v_mov_b32 v30, v14
    v_mov_b32 v14, 0
    v_mov_b32 v31, v15
    v_mov_b32 v15, 0
L_vna1:
L_w7:
    ds_read_b32 v36, v6 offset:4
    s_waitcnt lgkmcnt(0)
    v_readfirstlane_b32 s54, v36
    s_cmp_ge_u32 s54, s31
    s_cbranch_scc1 L_w7_ok
    s_sleep 1
    s_sub_u32 s72, s72, 1
    s_cbranch_scc1 L_end
    s_branch L_w7
L_w7_ok:
L_vn1:
    s_branch L_vloop
L_vdone:
    v_permlane16_swap_b32 v24, v28
    v_permlane16_swap_b32 v25, v29
    v_permlane16_swap_b32 v26, v30
    v_permlane16_swap_b32 v27, v31
    v_permlane16_swap_b32 v8, v12
    v_permlane16_swap_b32 v9, v13
    v_permlane16_swap_b32 v10, v14
    v_permlane16_swap_b32 v11, v15
    v_add_f32 v24, v24, v28
    v_add_f32 v25, v25, v29
    v_add_f32 v26, v26, v30
    v_add_f32 v27, v27, v31
    v_add_f32 v8, v8, v12
    v_add_f32 v9, v9, v13
    v_add_f32 v10, v10, v14
    v_add_f32 v11, v11, v15
    v_mov_b32 v16, 65535
    s_nop 0
    v_permlane32_swap_b32 v24, v8
    v_permlane32_swap_b32 v25, v9
    v_permlane32_swap_b32 v26, v10
    v_permlane32_swap_b32 v27, v11
    v_add_f32 v8, v8, v24
    v_add_f32 v9, v9, v25
    v_add_f32 v10, v10, v26
    v_add_f32 v11, v11, v27
    v_bfi_b32 v32, 1, v172, v8
    v_bfi_b32 v33, 1, v173, v9
    v_bfi_b32 v34, 1, v174, v10
    v_bfi_b32 v35, 1, v175, v11
    global_store_dwordx4 v154, v[32:35], s[26:27] sc1
    ds_write_b32 v152, v16
    s_endpgm
L_helper:
    v_mov_b32 v12, 0
    v_mov_b32 v13, 0
    v_mov_b32 v14, 0
    v_mov_b32 v15, 0
    ds_write_b128 v6, v[12:15] offset:0
    ds_write_b128 v6, v[12:15] offset:16
    ds_write_b128 v6, v[12:15] offset:32
    ds_write_b128 v6, v[12:15] offset:48
    v_and_b32 v20, 7, v0
    v_lshrrev_b32 v21, 3, v0
    v_lshlrev_b32 v21, 14, v21
    v_xor_b32 v22, v17, v20
    v_lshl_add_u32 v1, v22, 4, v21
    v_xor_b32 v22, 4, v22
    v_lshl_add_u32 v2, v22, 4, v21
    v_add_u32 v2, 131072, v2
    s_mov_b32 s22, 1048576
    s_mov_b32 s23, 0x20000
    s_mov_b32 s40, 0
    s_mov_b32 s49, 0
    s_lshl_b32 s45, s32, 7
    s_waitcnt lgkmcnt(0)
    s_mov_b32 s20, s10
    s_mov_b32 s21, s11
    s_lshl_b32 s66, s33, 16
    s_getreg_b32 s96, hwreg(HW_REG_XCC_ID)
    s_add_u32 s55, s96, 1
    s_bfe_u32 s56, s55, 65537
    s_lshl_b32 s56, s56, 16
    s_and_b32 s55, s55, 1
    s_lshl_b32 s55, s55, 15
    s_add_u32 s55, s55, s56
    s_add_u32 s55, s55, 524288
    s_lshr_b32 s54, s2, 2
    s_lshl_b32 s54, s54, 22
    s_add_u32 s54, s54, s55
    s_add_u32 s86, s6, s54
    s_addc_u32 s87, s7, 0
    s_add_u32 s88, s8, s54
    s_addc_u32 s89, s9, 0
    s_mov_b32 s94, 262401
    s_and_b32 s54, s96, 7
    s_lshl_b32 s54, s54, 29
    s_cmp_eq_u32 s2, 0
    s_cselect_b32 s54, s54, 0
    s_add_u32 s94, s94, s54
    s_bfe_u32 s96, s96, 65538
    s_lshr_b32 s50, s32, 2
    s_lshl_b32 s54, s33, 13
    s_add_u32 s55, s54, 1048576
    s_add_u32 s24, s18, s55
    s_addc_u32 s25, s19, 0
    s_mov_b32 s26, 139264
    s_mov_b32 s27, 0x20000
    s_lshl_b32 s54, s50, 7
    v_and_b32 v138, 15, v0
    v_lshl_add_u32 v138, v138, 3, s54
    v_lshl_add_u32 v138, v17, 9, v138
    s_and_b32 s54, s2, 3
    s_cbranch_scc1 L_nva
    s_mov_b32 s90, 2147450878
    s_mov_b32 s91, 2147450878
    s_mov_b32 s92, 2147450878
    s_mov_b32 s93, 2147450878
    s_bitcmp1_b32 s2, 3
    s_cbranch_scc1 L_ri8
    s_load_dword s90, s[86:87], 0 glc
    s_load_dword s92, s[86:87], 8192 glc
    s_branch L_rj8
L_ri8:
    s_load_dword s92, s[86:87], 8192 glc
    s_load_dword s90, s[86:87], 0 glc
L_rj8:
    s_mov_b32 s54, 0
    buffer_load_dwordx2 v[112:113], v138, s[24:27], s54 offen offset:0 sc1
    s_mov_b32 s54, 0
    buffer_load_dwordx2 v[114:115], v138, s[24:27], s54 offen offset:2048 sc1
    s_mov_b32 s54, 4096
    buffer_load_dwordx2 v[116:117], v138, s[24:27], s54 offen offset:0 sc1
    s_mov_b32 s54, 4096
    buffer_load_dwordx2 v[118:119], v138, s[24:27], s54 offen offset:2048 sc1
    s_mov_b32 s54, 131072
    buffer_load_dwordx2 v[120:121], v138, s[24:27], s54 offen offset:0 sc1
    s_mov_b32 s54, 131072
    buffer_load_dwordx2 v[122:123], v138, s[24:27], s54 offen offset:2048 sc1
    s_mov_b32 s54, 135168
    buffer_load_dwordx2 v[124:125], v138, s[24:27], s54 offen offset:0 sc1
    s_mov_b32 s54, 135168
    buffer_load_dwordx2 v[126:127], v138, s[24:27], s54 offen offset:2048 sc1
L_nva:
    s_mov_b32 s72, 0x100000
    v_lshlrev_b32 v3, 4, v0
    v_lshlrev_b32 v136, 3, v0
    v_mov_b32 v134, 0
    v_mov_b32 v135, 1
    s_lshl_b32 s51, s33, 3
    s_add_u32 s51, s51, s32
    s_lshl_b32 s54, s51, 13
    s_add_u32 s54, s54, 2097152
    s_add_u32 s28, s18, s54
    s_addc_u32 s29, s19, 0
    s_mov_b32 s30, 8192
    s_mov_b32 s31, 0x20000
    s_lshl_b32 s54, s33, 10
    s_add_u32 s54, s54, 3670016
    s_add_u32 s76, s18, s54
    s_addc_u32 s77, s19, 0
    s_mul_i32 s54, s33, 2304
    s_add_u32 s54, s54, 3145728
    s_add_u32 s74, s18, s54
    s_addc_u32 s75, s19, 0
    s_mov_b32 s78, 4096
    s_lshl_b32 s54, s32, 1
    s_add_u32 s54, s54, s34
    s_lshl_b32 s54, s54, 8
    s_add_u32 s14, s14, s54
    s_addc_u32 s15, s15, 0
    s_and_b32 s54, s2, 3
    s_cbranch_scc1 L_nvc
    s_mov_b32 s95, 150
L_rl9:
    s_sub_u32 s95, s95, 1
    s_cbranch_scc1 L_rd9
    s_cmp_lg_u32 s90, 2147450878
    s_cselect_b32 s54, 1, 0
    s_cmp_lg_u32 s92, 2147450878
    s_cselect_b32 s55, 1, 0
    s_or_b32 s56, s54, s55
    s_cbranch_scc0 L_rl9
    s_sub_i32 s54, s55, s54
    s_sub_i32 s55, 0, s54
    s_cmp_eq_u32 s96, 0
    s_cselect_b32 s54, s54, s55
    s_lshl_b32 s54, s54, 8
    s_add_u32 s94, s94, s54
L_rd9:
    s_waitcnt lgkmcnt(0)
    s_mov_b32 s90, 2147450878
    s_mov_b32 s91, 2147450878
    s_mov_b32 s92, 2147450878
    s_mov_b32 s93, 2147450878
    s_bitcmp1_b32 s2, 3
    s_cbranch_scc1 L_ri10
    s_load_dword s90, s[88:89], 0 glc
    s_load_dword s92, s[88:89], 8192 glc
    s_branch L_rj10
L_ri10:
    s_load_dword s92, s[88:89], 8192 glc
    s_load_dword s90, s[88:89], 0 glc
L_rj10:
    s_mov_b32 s95, 150
L_rl11:
    s_sub_u32 s95, s95, 1
    s_cbranch_scc1 L_rd11
    s_cmp_lg_u32 s90, 2147450878
    s_cselect_b32 s54, 1, 0
    s_cmp_lg_u32 s92, 2147450878
    s_cselect_b32 s55, 1, 0
    s_or_b32 s56, s54, s55
    s_cbranch_scc0 L_rl11
    s_sub_i32 s54, s55, s54
    s_sub_i32 s55, 0, s54
    s_cmp_eq_u32 s96, 0
    s_cselect_b32 s54, s54, s55
    s_lshl_b32 s54, s54, 18
    s_add_u32 s94, s94, s54
L_rd11:
    s_waitcnt lgkmcnt(0)
    v_mov_b32 v13, s94
    s_mov_b64 exec, 1
    s_waitcnt vmcnt(0)
    global_atomic_add v134, v13, s[16:17]
    s_mov_b64 exec, -1
L_nvc:
    s_lshl_b32 s42, s40, 11
    s_add_u32 s42, s42, s45
    s_add_u32 m0, s49, 0
    s_add_u32 s54, s42, 0
    buffer_load_dwordx4 v1, s[20:23], s54 offen  lds
    s_add_u32 m0, s49, 1024
    s_add_u32 s54, s42, 0
    buffer_load_dwordx4 v2, s[20:23], s54 offen  lds
    s_add_u32 m0, s49, 2048
    s_add_u32 s54, s42, 262144
    buffer_load_dwordx4 v1, s[20:23], s54 offen  lds
    s_add_u32 m0, s49, 3072
    s_add_u32 s54, s42, 262144
    buffer_load_dwordx4 v2, s[20:23], s54 offen  lds
    s_add_u32 m0, s49, 4096
    s_add_u32 s54, s42, 524288
    buffer_load_dwordx4 v1, s[20:23], s54 offen  lds
    s_add_u32 m0, s49, 5120
    s_add_u32 s54, s42, 524288
    buffer_load_dwordx4 v2, s[20:23], s54 offen  lds
    s_add_u32 m0, s49, 6144
    s_add_u32 s54, s42, 786432
    buffer_load_dwordx4 v1, s[20:23], s54 offen  lds
    s_add_u32 m0, s49, 7168
    s_add_u32 s54, s42, 786432
    buffer_load_dwordx4 v2, s[20:23], s54 offen  lds
    s_add_u32 s40, s40, 1
    s_add_u32 s49, s49, 8192
    s_lshl_b32 s42, s40, 11
    s_add_u32 s42, s42, s45
    s_add_u32 m0, s49, 0
    s_add_u32 s54, s42, 0
    buffer_load_dwordx4 v1, s[20:23], s54 offen  lds
    s_add_u32 m0, s49, 1024
    s_add_u32 s54, s42, 0
    buffer_load_dwordx4 v2, s[20:23], s54 offen  lds
    s_add_u32 m0, s49, 2048
    s_add_u32 s54, s42, 262144
    buffer_load_dwordx4 v1, s[20:23], s54 offen  lds
    s_add_u32 m0, s49, 3072
    s_add_u32 s54, s42, 262144
    buffer_load_dwordx4 v2, s[20:23], s54 offen  lds
    s_add_u32 m0, s49, 4096
    s_add_u32 s54, s42, 524288
    buffer_load_dwordx4 v1, s[20:23], s54 offen  lds
    s_add_u32 m0, s49, 5120
    s_add_u32 s54, s42, 524288
    buffer_load_dwordx4 v2, s[20:23], s54 offen  lds
    s_add_u32 m0, s49, 6144
    s_add_u32 s54, s42, 786432
    buffer_load_dwordx4 v1, s[20:23], s54 offen  lds
    s_add_u32 m0, s49, 7168
    s_add_u32 s54, s42, 786432
    buffer_load_dwordx4 v2, s[20:23], s54 offen  lds
    s_add_u32 s40, s40, 1
    s_add_u32 s49, s49, 8192
    v_lshrrev_b32 v1, 3, v0
    v_and_b32 v2, 7, v0
    v_lshlrev_b32 v13, 7, v1
    v_lshlrev_b32 v1, 14, v1
    v_lshl_add_u32 v1, v2, 4, v1
    v_and_b32 v2, 3, v0
    v_xor_b32 v2, v2, v17
    v_lshl_add_u32 v200, v2, 4, v13
    v_xor_b32 v201, 32, v200
    v_xor_b32 v202, 64, v200
    v_xor_b32 v203, 96, v200
    v_mov_b32 v22, v17
    s_lshl_b32 s52, s32, 9
    v_mul_u32_u24 v133, 1152, v0
    s_waitcnt vmcnt(8)
    v_mov_b32 v12, 1
    ds_write_b32 v6, v12 offset:0
    s_waitcnt lgkmcnt(0)
    s_barrier
    s_waitcnt vmcnt(0)
    v_mov_b32 v12, 2
    ds_write_b32 v6, v12 offset:0
L_w12:
    ds_read_b128 v[12:15], v6 offset:16
    s_waitcnt lgkmcnt(0)
    v_min3_u32 v12, v12, v13, v14
    v_min_u32 v12, v12, v15
    s_nop 0
    v_readfirstlane_b32 s54, v12
    s_cmp_ge_u32 s54, 4
    s_cbranch_scc1 L_w12_ok
    s_sleep 2
    s_sub_u32 s72, s72, 1
    s_cbranch_scc1 L_end
    s_branch L_w12
L_w12_ok:
L_w13:
    global_load_dword v12, v134, s[16:17] sc1
    s_waitcnt vmcnt(0)
    v_readfirstlane_b32 s55, v12
    s_and_b32 s54, s55, 0xff
    s_cmp_ge_u32 s54, 64
    s_cbranch_scc1 L_w13_ok
    s_sleep 8
    s_sub_u32 s72, s72, 1
    s_cbranch_scc1 L_end
    s_branch L_w13
L_w13_ok:
    s_lshr_b32 s54, s55, 29
    s_add_u32 s54, s54, s32
    s_bfe_u32 s56, s54, 65538
    s_and_b32 s54, s54, 3
    s_lshr_b32 s57, s32, 3
    s_lshl_b32 s57, s57, 2
    s_or_b32 s54, s54, s57
    s_mul_i32 s57, s56, 1152
    v_mov_b32 v139, s57
    s_and_b32 s57, s33, 1
    s_xor_b32 s56, s56, s57
    s_bfe_u32 s57, s55, 655368
    s_cmp_gt_u32 s57, 64
    s_cselect_b32 s57, 1, 0
    s_xor_b32 s57, s57, s56
    s_bfe_u32 s58, s55, 655378
    s_cmp_gt_u32 s58, 64
    s_cselect_b32 s58, 1, 0
    s_xor_b32 s53, s58, s56
    s_bfe_u32 s45, s54, 65536
    s_lshl_b32 s45, s45, 8
    s_bfe_u32 s59, s54, 65537
    s_lshl_b32 s59, s59, 9
    s_or_b32 s45, s45, s59
    s_bfe_u32 s59, s54, 65538
    s_lshl_b32 s59, s59, 10
    s_or_b32 s45, s45, s59
    s_lshl_b32 s54, s57, 6
    s_or_b32 s54, s54, s45
    s_lshl_b32 s54, s54, 7
    s_or_b32 s54, s54, s53
    s_or_b32 s54, s54, 0x80000000
    v_mov_b32 v12, s54
    ds_write_b32 v6, v12 offset:8
    s_lshl_b32 s83, s57, 2
    s_lshl_b32 s82, 0x0f0f0f0f, s83
    s_mov_b32 s83, s82
    s_mov_b32 s81, s45
    s_andn2_b32 s45, s45, 32
    s_mov_b32 s40, 2
    s_mov_b32 s84, 16384
    s_add_u32 s41, s52, 131072
    v_lshlrev_b32 v204, 14, v22
    v_and_b32 v13, 15, v0
    v_lshl_add_u32 v204, v13, 4, v204
    s_mov_b32 s90, 1048576
    s_mov_b32 s91, 0x20000
    s_mov_b32 s55, 2
    s_cmp_ge_u32 s55, 10
    s_cselect_b32 s88, s12, s10
    s_cselect_b32 s89, s13, s11
    s_cselect_b32 s54, 6, 0
    s_add_u32 s54, s54, s55
    s_and_b32 s54, s54, 7
    s_lshl_b32 s54, s54, 11
    s_add_u32 s54, s54, s45
    s_add_u32 s54, s54, s66
    s_cmp_ge_u32 s55, 18
    s_cselect_b32 s90, 0, s90
    buffer_load_dwordx4 v[208:211], v204, s[88:91], s54 offen
    s_mov_b32 s55, 3
    s_cmp_ge_u32 s55, 10
    s_cselect_b32 s88, s12, s10
    s_cselect_b32 s89, s13, s11
    s_cselect_b32 s54, 6, 0
    s_add_u32 s54, s54, s55
    s_and_b32 s54, s54, 7
    s_lshl_b32 s54, s54, 11
    s_add_u32 s54, s54, s45
    s_add_u32 s54, s54, s66
    s_cmp_ge_u32 s55, 18
    s_cselect_b32 s90, 0, s90
    buffer_load_dwordx4 v[208:211], v204, s[88:91], s54 offen
    s_waitcnt vmcnt(1)
    s_and_b32 s42, s40, 7
    s_lshl_b32 s42, s42, 11
    s_add_u32 s42, s42, s45
    s_add_u32 s54, s42, 0
    buffer_load_dwordx4 v[48:51], v1, s[20:23], s54 offen
    s_add_u32 s54, s42, 131072
    buffer_load_dwordx4 v[52:55], v1, s[20:23], s54 offen
    s_add_u32 s54, s42, 262144
    buffer_load_dwordx4 v[56:59], v1, s[20:23], s54 offen
    s_add_u32 s54, s42, 393216
    buffer_load_dwordx4 v[60:63], v1, s[20:23], s54 offen
    s_add_u32 s54, s42, 524288
    buffer_load_dwordx4 v[64:67], v1, s[20:23], s54 offen
    s_add_u32 s54, s42, 655360
    buffer_load_dwordx4 v[68:71], v1, s[20:23], s54 offen
    s_add_u32 s54, s42, 786432
    buffer_load_dwordx4 v[72:75], v1, s[20:23], s54 offen
    s_add_u32 s54, s42, 917504
    buffer_load_dwordx4 v[76:79], v1, s[20:23], s54 offen
    s_add_u32 s54, s42, 128
    buffer_load_dwordx4 v[80:83], v1, s[20:23], s54 offen
    s_add_u32 s54, s42, 131200
    buffer_load_dwordx4 v[84:87], v1, s[20:23], s54 offen
    s_add_u32 s54, s42, 262272
    buffer_load_dwordx4 v[88:91], v1, s[20:23], s54 offen
    s_add_u32 s54, s42, 393344
    buffer_load_dwordx4 v[92:95], v1, s[20:23], s54 offen
    s_add_u32 s54, s42, 524416
    buffer_load_dwordx4 v[96:99], v1, s[20:23], s54 offen
    s_add_u32 s54, s42, 655488
    buffer_load_dwordx4 v[100:103], v1, s[20:23], s54 offen
    s_add_u32 s54, s42, 786560
    buffer_load_dwordx4 v[104:107], v1, s[20:23], s54 offen
    s_add_u32 s54, s42, 917632
    buffer_load_dwordx4 v[108:111], v1, s[20:23], s54 offen
    s_mov_b32 s55, 4
    s_cmp_ge_u32 s55, 10
    s_cselect_b32 s88, s12, s10
    s_cselect_b32 s89, s13, s11
    s_cselect_b32 s54, 6, 0
    s_add_u32 s54, s54, s55
    s_and_b32 s54, s54, 7
    s_lshl_b32 s54, s54, 11
    s_add_u32 s54, s54, s45
    s_add_u32 s54, s54, s66
    s_cmp_ge_u32 s55, 18
    s_cselect_b32 s90, 0, s90
    buffer_load_dwordx4 v[208:211], v204, s[88:91], s54 offen
L_he:
    s_cmp_lg_u32 s40, 8
    s_cbranch_scc1 L_he1
L_w14:
    ds_read_b128 v[12:15], v6 offset:16
    s_waitcnt lgkmcnt(0)
    v_min3_u32 v12, v12, v13, v14
    v_min_u32 v12, v12, v15
    s_nop 0
    v_readfirstlane_b32 s54, v12
    s_cmp_ge_u32 s54, 8
    s_cbranch_scc1 L_w14_ok
    s_sleep 4
    s_sub_u32 s72, s72, 1
    s_cbranch_scc1 L_end
    s_branch L_w14
L_w14_ok:
    s_mov_b32 s84, 0
L_he1:
    s_cmp_lg_u32 s40, 10
    s_cbranch_scc1 L_he2
    s_lshl_b32 s83, s53, 2
    s_lshl_b32 s82, 0x0f0f0f0f, s83
    s_mov_b32 s83, s82
    s_mov_b32 s84, 65536
L_he2:
    s_add_u32 s40, s40, 1
    s_mov_b32 s80, s42
    s_cmp_ge_u32 s40, 10
    s_cselect_b32 s54, 6, 0
    s_add_u32 s42, s40, s54
    s_and_b32 s42, s42, 7
    s_lshl_b32 s42, s42, 11
    s_add_u32 s42, s42, s45
    v_add_u32 v16, s84, v200
    v_add_u32 v18, s84, v202
    s_waitcnt vmcnt(9)
    s_mov_b64 exec, s[82:83]
    ds_write_b128 v16, v[48:51] offset:0
    ds_write_b128 v18, v[52:55] offset:1024
    ds_write_b128 v16, v[56:59] offset:2048
    ds_write_b128 v18, v[60:63] offset:3072
    ds_write_b128 v16, v[64:67] offset:4096
    ds_write_b128 v18, v[68:71] offset:5120
    ds_write_b128 v16, v[72:75] offset:6144
    ds_write_b128 v18, v[76:79] offset:7168
    s_mov_b64 exec, -1
    s_waitcnt lgkmcnt(0)
    s_cmp_lg_u32 s40, 10
    s_cbranch_scc1 L_he3
    s_mov_b32 s20, s12
    s_mov_b32 s21, s13
L_he3:
    s_cmp_ge_u32 s40, 18
    s_cselect_b32 s22, 0, s22
    s_add_u32 s54, s42, 0
    buffer_load_dwordx4 v[48:51], v1, s[20:23], s54 offen
    s_add_u32 s54, s42, 131072
    buffer_load_dwordx4 v[52:55], v1, s[20:23], s54 offen
    s_add_u32 s54, s42, 262144
    buffer_load_dwordx4 v[56:59], v1, s[20:23], s54 offen
    s_add_u32 s54, s42, 393216
    buffer_load_dwordx4 v[60:63], v1, s[20:23], s54 offen
    s_add_u32 s54, s42, 524288
    buffer_load_dwordx4 v[64:67], v1, s[20:23], s54 offen
    s_add_u32 s54, s42, 655360
    buffer_load_dwordx4 v[68:71], v1, s[20:23], s54 offen
    s_add_u32 s54, s42, 786432
    buffer_load_dwordx4 v[72:75], v1, s[20:23], s54 offen
    s_add_u32 s54, s42, 917504
    buffer_load_dwordx4 v[76:79], v1, s[20:23], s54 offen
    s_waitcnt vmcnt(9)
    s_mov_b64 exec, s[82:83]
    ds_write_b128 v18, v[80:83] offset:0
    ds_write_b128 v16, v[84:87] offset:1024
    ds_write_b128 v18, v[88:91] offset:2048
    ds_write_b128 v16, v[92:95] offset:3072
    ds_write_b128 v18, v[96:99] offset:4096
    ds_write_b128 v16, v[100:103] offset:5120
    ds_write_b128 v18, v[104:107] offset:6144
    ds_write_b128 v16, v[108:111] offset:7168
    s_mov_b64 exec, -1
    s_waitcnt lgkmcnt(0)
    s_add_u32 s54, s42, 128
    buffer_load_dwordx4 v[80:83], v1, s[20:23], s54 offen
    s_add_u32 s54, s42, 131200
    buffer_load_dwordx4 v[84:87], v1, s[20:23], s54 offen
    s_add_u32 s54, s42, 262272
    buffer_load_dwordx4 v[88:91], v1, s[20:23], s54 offen
    s_add_u32 s54, s42, 393344
    buffer_load_dwordx4 v[92:95], v1, s[20:23], s54 offen
    s_add_u32 s54, s42, 524416
    buffer_load_dwordx4 v[96:99], v1, s[20:23], s54 offen
    s_add_u32 s54, s42, 655488
    buffer_load_dwordx4 v[100:103], v1, s[20:23], s54 offen
    s_add_u32 s54, s42, 786560
    buffer_load_dwordx4 v[104:107], v1, s[20:23], s54 offen
    s_add_u32 s54, s42, 917632
    buffer_load_dwordx4 v[108:111], v1, s[20:23], s54 offen
    s_add_u32 s55, s40, 2
    s_cmp_ge_u32 s55, 10
    s_cselect_b32 s88, s12, s10
    s_cselect_b32 s89, s13, s11
    s_cselect_b32 s54, 6, 0
    s_add_u32 s54, s54, s55
    s_and_b32 s54, s54, 7
    s_lshl_b32 s54, s54, 11
    s_add_u32 s54, s54, s45
    s_add_u32 s54, s54, s66
    s_cmp_ge_u32 s55, 18
    s_cselect_b32 s90, 0, s90
    buffer_load_dwordx4 v[208:211], v204, s[88:91], s54 offen
    s_add_u32 s84, s84, 8192
    s_min_u32 s54, s40, 10
    s_cmp_eq_u32 s54, 9
    s_cselect_b32 s54, 8, s54
    v_mov_b32 v12, s54
    ds_write_b32 v6, v12 offset:0
    s_cmp_lg_u32 s40, 10
    s_cbranch_scc1 L_hnp
    buffer_load_dwordx2 v[172:173], v136, s[24:27], s52 offen sc1
    buffer_load_dwordx2 v[174:175], v136, s[24:27], s41 offen sc1
    global_load_dwordx2 v[196:197], v136, s[76:77] sc1
    global_load_dwordx2 v[198:199], v136, s[76:77] offset:512 sc1
    s_cmp_ge_u32 s32, 8
    s_cbranch_scc1 L_hnq
    buffer_load_dwordx4 v[140:143], v3, s[28:31], 0 offen offset:0 sc1
    buffer_load_dwordx4 v[144:147], v3, s[28:31], 0 offen offset:1024 sc1
    buffer_load_dwordx4 v[148:151], v3, s[28:31], 0 offen offset:2048 sc1
    buffer_load_dwordx4 v[152:155], v3, s[28:31], 0 offen offset:3072 sc1
    buffer_load_dwordx4 v[156:159], v3, s[28:31], s78 offen offset:0 sc1
    buffer_load_dwordx4 v[160:163], v3, s[28:31], s78 offen offset:1024 sc1
    buffer_load_dwordx4 v[164:167], v3, s[28:31], s78 offen offset:2048 sc1
    buffer_load_dwordx4 v[168:171], v3, s[28:31], s78 offen offset:3072 sc1
    s_cmp_lg_u32 s32, 0
    s_cbranch_scc1 L_hnq
    s_mov_b64 exec, 3
    global_store_dword v133, v134, s[74:75] sc1
    s_mov_b64 exec, -1
L_hnq:
    s_waitcnt vmcnt(0)
L_hnp:
    s_cmp_lt_u32 s40, 18
    s_cbranch_scc1 L_he
    s_waitcnt vmcnt(0)
    s_mov_b32 s22, 1048576
    v_bfe_u32 v18, v0, 3, 1
    v_bfe_u32 v19, v0, 4, 1
    v_lshlrev_b32 v19, 2, v19
    v_or_b32 v18, v18, v19
    v_and_b32 v19, 3, v0
    v_lshlrev_b32 v19, 1, v19
    v_xor_b32 v18, v18, v19
    v_lshlrev_b32 v18, 4, v18
    v_bfe_u32 v19, v0, 2, 2
    v_lshl_add_u32 v19, v22, 3, v19
    v_lshl_add_u32 v8, v19, 7, v18
    v_xor_b32 v9, 16, v8
    v_xor_b32 v10, 32, v8
    v_add_u32 v10, 512, v10
    v_xor_b32 v11, 16, v10
    v_and_b32 v4, 3, v0
    v_lshlrev_b32 v4, 5, v4
    v_bfe_u32 v5, v0, 2, 2
    v_lshl_add_u32 v4, v5, 3, v4
    v_lshl_add_u32 v4, v22, 7, v4
    v_add_u32 v4, 149504, v4
    v_and_b32 v5, 3, v0
    v_lshlrev_b32 v5, 7, v5
    v_lshl_add_u32 v5, v22, 4, v5
    v_add_u32 v5, 149504, v5
    v_and_b32 v7, 3, v0
    v_lshlrev_b32 v7, 8, v7
    v_lshl_add_u32 v7, v22, 4, v7
    s_mov_b32 s60, 0x000f000f
    s_mov_b32 s61, 0x000f000f
    s_mov_b32 s43, 0
    s_lshl_b32 s54, s50, 4
    s_lshl_b64 s[62:63], 0xffff, s54
    s_mov_b32 s64, 0x80000000
    v_add_u32 v137, 147456, v3
    v_not_b32 v172, v172
    v_not_b32 v173, v173
    v_not_b32 v174, v174
    v_not_b32 v175, v175
    s_mov_b32 s92, 0x457ff000
    s_mov_b32 s93, 0x39800801
    s_mov_b32 s94, 0x7ffc0
L_hset:
    s_lshl_b32 s44, s43, 5
    s_add_u32 s44, s44, 33
L_w15:
    ds_read_b128 v[12:15], v6 offset:16
    s_waitcnt lgkmcnt(0)
    v_min3_u32 v12, v12, v13, v14
    v_min_u32 v12, v12, v15
    s_nop 0
    v_readfirstlane_b32 s54, v12
    s_cmp_ge_u32 s54, s44
    s_cbranch_scc1 L_w15_ok
    s_sleep 4
    s_sub_u32 s72, s72, 1
    s_cbranch_scc1 L_end
    s_branch L_w15
L_w15_ok:
    ds_read_b128 v[80:83], v137
    s_lshl_b32 s41, s43, 17
    s_add_u32 s55, s52, s41
    s_waitcnt lgkmcnt(0)
    v_and_b32 v84, 0x7fffffff, v80
    v_and_b32 v85, 0x7fffffff, v81
    v_and_b32 v86, 0x7fffffff, v82
    v_and_b32 v87, 0x7fffffff, v83
    v_max3_u32 v84, v84, v85, v86
    v_max_u32 v84, v84, v87
    v_lshrrev_b32 v84, 23, v84
    v_max_u32 v84, 16, v84
    v_sub_u32 v85, 126, v84
    v_ldexp_f32 v85, s92, v85
    v_add_u32 v86, 1, v84
    v_lshrrev_b32 v86, 8, v86
    v_mul_u32_u24 v86, 768, v86
    v_or_b32 v84, v84, v86
    v_mul_f32 v80, v80, v85
    v_cvt_rpi_i32_f32 v80, v80
    v_mul_f32 v81, v81, v85
    v_cvt_rpi_i32_f32 v81, v81
    v_mul_f32 v82, v82, v85
    v_cvt_rpi_i32_f32 v82, v82
    v_mul_f32 v83, v83, v85
    v_cvt_rpi_i32_f32 v83, v83
    v_and_b32 v86, 31, v84
    v_lshrrev_b32 v87, 5, v84
    v_lshlrev_b32 v86, 1, v86
    v_bfi_b32 v86, 1, v172, v86
    v_lshlrev_b32 v80, 6, v80
    v_bfi_b32 v86, s94, v80, v86
    v_lshl_or_b32 v86, v81, 19, v86
    v_lshlrev_b32 v87, 1, v87
    v_bfi_b32 v87, 1, v173, v87
    v_lshlrev_b32 v82, 6, v82
    v_bfi_b32 v87, s94, v82, v87
    v_lshl_or_b32 v87, v83, 19, v87
    v_sub_u32 v84, v137, v136
    ds_write_b64 v84, v[86:87]
    s_waitcnt lgkmcnt(0)
    ds_read_b128 v[80:83], v137
    s_mov_b32 exec_hi, 0
    s_waitcnt lgkmcnt(0)
    buffer_store_dwordx4 v[80:83], v3, s[24:27], s55 offen sc1
    s_mov_b32 exec_hi, -1
    v_mov_b32 v172, v174
    v_mov_b32 v173, v175
    v_add_u32 v137, 1024, v137
    s_and_b32 s54, s32, 3
    s_cbranch_scc1 L_hcons
    s_cmp_eq_u32 s43, 0
    s_cselect_b32 s44, 36, 68
L_w16:
    ds_read_b128 v[12:15], v6 offset:16
    s_waitcnt lgkmcnt(0)
    v_min3_u32 v12, v12, v13, v14
    v_min_u32 v12, v12, v15
    s_nop 0
    v_readfirstlane_b32 s54, v12
    s_cmp_ge_u32 s54, s44
    s_cbranch_scc1 L_w16_ok
    s_sleep 8
    s_sub_u32 s72, s72, 1
    s_cbranch_scc1 L_end
    s_branch L_w16
L_w16_ok:
L_hpoll:
    s_add_u32 s55, s41, 0
    buffer_load_dwordx2 v[88:89], v138, s[24:27], s55 offen offset:0 sc1
    s_add_u32 s55, s41, 0
    buffer_load_dwordx2 v[90:91], v138, s[24:27], s55 offen offset:2048 sc1
    s_add_u32 s55, s41, 4096
    buffer_load_dwordx2 v[92:93], v138, s[24:27], s55 offen offset:0 sc1
    s_add_u32 s55, s41, 4096
    buffer_load_dwordx2 v[94:95], v138, s[24:27], s55 offen offset:2048 sc1
    s_waitcnt vmcnt(0)
    v_xor_b32 v12, v88, v112
    v_bitop3_b32 v12, v12, v89, v113 bitop3:0x60
    v_bitop3_b32 v12, v12, v90, v114 bitop3:0x60
    v_bitop3_b32 v12, v12, v91, v115 bitop3:0x60
    v_bitop3_b32 v12, v12, v92, v116 bitop3:0x60
    v_bitop3_b32 v12, v12, v93, v117 bitop3:0x60
    v_bitop3_b32 v12, v12, v94, v118 bitop3:0x60
    v_bitop3_b32 v12, v12, v95, v119 bitop3:0x60
    v_and_b32 v12, 1, v12
    v_cmp_eq_u32 vcc, 0, v12
    s_nop 4
    s_cbranch_vccz L_hpoll_ok
    s_sleep 16
    s_sub_u32 s72, s72, 1
    s_cbranch_scc1 L_end
    s_branch L_hpoll
L_hpoll_ok:
    v_bfe_u32 v84, v88, 1, 5
    v_bfe_u32 v85, v89, 1, 5
    v_lshl_or_b32 v84, v85, 5, v84
    v_subrev_u32 v84, 126, v84
    v_ldexp_f32 v84, s93, v84
    v_bfe_i32 v85, v88, 6, 13
    v_cvt_f32_i32 v85, v85
    v_mul_f32 v80, v84, v85
    v_ashrrev_i32 v85, 19, v88
    v_cvt_f32_i32 v85, v85
    v_mul_f32 v81, v84, v85
    v_bfe_i32 v85, v89, 6, 13
    v_cvt_f32_i32 v85, v85
    v_mul_f32 v82, v84, v85
    v_ashrrev_i32 v85, 19, v89
    v_cvt_f32_i32 v85, v85
    v_mul_f32 v83, v84, v85
    v_bfe_u32 v84, v90, 1, 5
    v_bfe_u32 v85, v91, 1, 5
    v_lshl_or_b32 v84, v85, 5, v84
    v_subrev_u32 v84, 126, v84
    v_ldexp_f32 v84, s93, v84
    v_bfe_i32 v85, v90, 6, 13
    v_cvt_f32_i32 v85, v85
    v_fmac_f32 v80, v84, v85
    v_ashrrev_i32 v85, 19, v90
    v_cvt_f32_i32 v85, v85
    v_fmac_f32 v81, v84, v85
    v_bfe_i32 v85, v91, 6, 13
    v_cvt_f32_i32 v85, v85
    v_fmac_f32 v82, v84, v85
    v_ashrrev_i32 v85, 19, v91
    v_cvt_f32_i32 v85, v85
    v_fmac_f32 v83, v84, v85
    v_bfe_u32 v84, v92, 1, 5
    v_bfe_u32 v85, v93, 1, 5
    v_lshl_or_b32 v84, v85, 5, v84
    v_subrev_u32 v84, 126, v84
    v_ldexp_f32 v84, s93, v84
    v_bfe_i32 v85, v92, 6, 13
    v_cvt_f32_i32 v85, v85
    v_fmac_f32 v80, v84, v85
    v_ashrrev_i32 v85, 19, v92
    v_cvt_f32_i32 v85, v85
    v_fmac_f32 v81, v84, v85
    v_bfe_i32 v85, v93, 6, 13
    v_cvt_f32_i32 v85, v85
    v_fmac_f32 v82, v84, v85
    v_ashrrev_i32 v85, 19, v93
    v_cvt_f32_i32 v85, v85
    v_fmac_f32 v83, v84, v85
    v_bfe_u32 v84, v94, 1, 5
    v_bfe_u32 v85, v95, 1, 5
    v_lshl_or_b32 v84, v85, 5, v84
    v_subrev_u32 v84, 126, v84
    v_ldexp_f32 v84, s93, v84
    v_bfe_i32 v85, v94, 6, 13
    v_cvt_f32_i32 v85, v85
    v_fmac_f32 v80, v84, v85
    v_ashrrev_i32 v85, 19, v94
    v_cvt_f32_i32 v85, v85
    v_fmac_f32 v81, v84, v85
    v_bfe_i32 v85, v95, 6, 13
    v_cvt_f32_i32 v85, v85
    v_fmac_f32 v82, v84, v85
    v_ashrrev_i32 v85, 19, v95
    v_cvt_f32_i32 v85, v85
    v_fmac_f32 v83, v84, v85
    v_mov_b32 v84, v80
    v_mov_b32 v85, v81
    v_mov_b32 v86, v82
    v_mov_b32 v87, v83
    s_nop 0
    v_permlane16_swap_b32 v80, v84
    v_permlane16_swap_b32 v81, v85
    v_permlane16_swap_b32 v82, v86
    v_permlane16_swap_b32 v83, v87
    v_add_f32 v80, v80, v84
    v_add_f32 v81, v81, v85
    v_add_f32 v82, v82, v86
    v_add_f32 v83, v83, v87
    v_mov_b32 v84, v80
    v_mov_b32 v85, v81
    v_mov_b32 v86, v82
    v_mov_b32 v87, v83
    s_nop 0
    v_permlane32_swap_b32 v80, v84
    v_permlane32_swap_b32 v81, v85
    v_permlane32_swap_b32 v82, v86
    v_permlane32_swap_b32 v83, v87
    v_add_f32 v80, v80, v84
    v_add_f32 v81, v81, v85
    v_add_f32 v82, v82, v86
    v_add_f32 v83, v83, v87
    v_cvt_pk_bf16_f32 v80, v80, v80
    v_and_b32 v80, 0xffff0000, v80
    v_mul_f32 v80, 0x3db504f3, v80
    v_cvt_pk_bf16_f32 v80, v80, v80
    v_and_b32 v80, 0xffff0000, v80
    v_cvt_pk_bf16_f32 v81, v81, v81
    v_and_b32 v81, 0xffff0000, v81
    v_mul_f32 v81, 0x3db504f3, v81
    v_cvt_pk_bf16_f32 v81, v81, v81
    v_and_b32 v81, 0xffff0000, v81
    v_cvt_pk_bf16_f32 v82, v82, v82
    v_and_b32 v82, 0xffff0000, v82
    v_mul_f32 v82, 0x3db504f3, v82
    v_cvt_pk_bf16_f32 v82, v82, v82
    v_and_b32 v82, 0xffff0000, v82
    v_cvt_pk_bf16_f32 v83, v83, v83
    v_and_b32 v83, 0xffff0000, v83
    v_mul_f32 v83, 0x3db504f3, v83
    v_cvt_pk_bf16_f32 v83, v83, v83
    v_and_b32 v83, 0xffff0000, v83
    v_max3_f32 v12, v80, v81, v82
    v_max_f32 v12, v12, v83
    s_nop 1
    v_max_f32_dpp v12, v12, v12 row_ror:8 row_mask:0xf bank_mask:0xf
    s_nop 1
    v_max_f32_dpp v12, v12, v12 row_ror:4 row_mask:0xf bank_mask:0xf
    s_nop 1
    v_max_f32_dpp v12, v12, v12 row_ror:2 row_mask:0xf bank_mask:0xf
    s_nop 1
    v_max_f32_dpp v12, v12, v12 row_ror:1 row_mask:0xf bank_mask:0xf
    v_sub_f32 v80, v80, v12
    v_mul_f32 v80, 0x3fb8aa3b, v80
    v_exp_f32 v80, v80
    v_sub_f32 v81, v81, v12
    v_mul_f32 v81, 0x3fb8aa3b, v81
    v_exp_f32 v81, v81
    v_sub_f32 v82, v82, v12
    v_mul_f32 v82, 0x3fb8aa3b, v82
    v_exp_f32 v82, v82
    v_sub_f32 v83, v83, v12
    v_mul_f32 v83, 0x3fb8aa3b, v83
    v_exp_f32 v83, v83
    s_nop 0
    v_add_f32 v12, v80, v81
    v_add_f32 v13, v82, v83
    v_add_f32 v12, v12, v13
    s_nop 1
    v_add_f32_dpp v12, v12, v12 row_ror:8 row_mask:0xf bank_mask:0xf
    s_nop 1
    v_add_f32_dpp v12, v12, v12 row_ror:4 row_mask:0xf bank_mask:0xf
    s_nop 1
    v_add_f32_dpp v12, v12, v12 row_ror:2 row_mask:0xf bank_mask:0xf
    s_nop 1
    v_add_f32_dpp v12, v12, v12 row_ror:1 row_mask:0xf bank_mask:0xf
    v_rcp_f32 v12, v12
    v_not_b32 v84, v196
    v_not_b32 v85, v197
    v_mul_f32 v80, v80, v12
    v_mul_f32 v81, v81, v12
    v_mul_f32 v82, v82, v12
    v_mul_f32 v83, v83, v12
    v_cvt_pk_bf16_f32 v14, v80, v81
    v_cvt_pk_bf16_f32 v15, v82, v83
    v_bfi_b32 v14, s64, v84, v14
    v_bfi_b32 v15, s64, v85, v15
    s_mov_b64 exec, s[62:63]
    global_store_dwordx2 v136, v[14:15], s[76:77] sc1
    s_mov_b64 exec, -1
    v_mov_b32 v112, v120
    v_mov_b32 v113, v121
    v_mov_b32 v114, v122
    v_mov_b32 v115, v123
    v_mov_b32 v116, v124
    v_mov_b32 v117, v125
    v_mov_b32 v118, v126
    v_mov_b32 v119, v127
L_hcons:
    s_cmp_eq_u32 s43, 0
    s_cselect_b32 s44, 48, 80
L_w17:
    ds_read_b128 v[12:15], v6 offset:16
    s_waitcnt lgkmcnt(0)
    v_min3_u32 v12, v12, v13, v14
    v_min_u32 v12, v12, v15
    s_nop 0
    v_readfirstlane_b32 s54, v12
    s_cmp_ge_u32 s54, s44
    s_cbranch_scc1 L_w17_ok
    s_sleep 8
    s_sub_u32 s72, s72, 1
    s_cbranch_scc1 L_end
    s_branch L_w17
L_w17_ok:
L_hpp:
    global_load_dwordx2 v[80:81], v136, s[76:77] sc1
    s_waitcnt vmcnt(0)
    v_xor_b32 v12, v80, v196
    v_bitop3_b32 v12, v12, v81, v197 bitop3:0x60
    v_cmp_le_i32 vcc, 0, v12
    s_nop 4
    s_cbranch_vccz L_hpp_ok
    s_sleep 8
    s_sub_u32 s72, s72, 1
    s_cbranch_scc1 L_end
    s_branch L_hpp
L_hpp_ok:
    v_and_b32 v80, 0x7fffffff, v80
    v_and_b32 v81, 0x7fffffff, v81
    v_mov_b32 v196, v198
    v_mov_b32 v197, v199
    ds_write_b64 v4, v[80:81]
    s_waitcnt lgkmcnt(0)
    ds_read_b128 v[24:27], v5
    ds_read_b128 v[28:31], v5 offset:64
    s_waitcnt lgkmcnt(0)
    v_add_u32 v128, 65536, v8
    v_add_u32 v129, 65536, v9
    v_add_u32 v130, 65536, v10
    v_add_u32 v131, 65536, v11
    s_lshl_b32 s54, s43, 13
    s_add_u32 s54, s54, 131072
    v_add_u32 v132, s54, v7
    s_cmp_eq_u32 s43, 0
    s_cselect_b32 s40, 8, 6
L_hw:
    ds_read_b64_tr_b16 v[180:181], v128 offset:0
    ds_read_b64_tr_b16 v[182:183], v130 offset:0
    ds_read_b64_tr_b16 v[184:185], v128 offset:4096
    ds_read_b64_tr_b16 v[186:187], v130 offset:4096
    ds_read_b64_tr_b16 v[188:189], v128 offset:8
    ds_read_b64_tr_b16 v[190:191], v130 offset:8
    ds_read_b64_tr_b16 v[192:193], v128 offset:4104
    ds_read_b64_tr_b16 v[194:195], v130 offset:4104
    ds_read_b64_tr_b16 v[216:217], v129 offset:0
    ds_read_b64_tr_b16 v[218:219], v131 offset:0
    ds_read_b64_tr_b16 v[220:221], v129 offset:4096
    ds_read_b64_tr_b16 v[222:223], v131 offset:4096
    ds_read_b64_tr_b16 v[224:225], v129 offset:8
    ds_read_b64_tr_b16 v[226:227], v131 offset:8
    ds_read_b64_tr_b16 v[228:229], v129 offset:4104
    ds_read_b64_tr_b16 v[230:231], v131 offset:4104
    s_waitcnt lgkmcnt(12)
    v_mfma_f32_16x16x32_bf16 v[32:35], v[180:183], v[24:27], 0
    v_mfma_f32_16x16x32_bf16 v[32:35], v[184:187], v[28:31], v[32:35]
    s_waitcnt lgkmcnt(8)
    v_mfma_f32_16x16x32_bf16 v[36:39], v[188:191], v[24:27], 0
    v_mfma_f32_16x16x32_bf16 v[36:39], v[192:195], v[28:31], v[36:39]
    s_waitcnt lgkmcnt(4)
    v_mfma_f32_16x16x32_bf16 v[40:43], v[216:219], v[24:27], 0
    v_mfma_f32_16x16x32_bf16 v[40:43], v[220:223], v[28:31], v[40:43]
    s_waitcnt lgkmcnt(0)
    v_mfma_f32_16x16x32_bf16 v[44:47], v[224:227], v[24:27], 0
    v_mfma_f32_16x16x32_bf16 v[44:47], v[228:231], v[28:31], v[44:47]
    s_nop 7
    s_mov_b64 exec, s[60:61]
    ds_write2_b32 v132, v32, v36 offset0:0 offset1:1
    ds_write2_b32 v132, v40, v44 offset0:2 offset1:3
    ds_write2_b32 v132, v33, v37 offset0:16 offset1:17
    ds_write2_b32 v132, v41, v45 offset0:18 offset1:19
    ds_write2_b32 v132, v34, v38 offset0:32 offset1:33
    ds_write2_b32 v132, v42, v46 offset0:34 offset1:35
    ds_write2_b32 v132, v35, v39 offset0:48 offset1:49
    ds_write2_b32 v132, v43, v47 offset0:50 offset1:51
    s_mov_b64 exec, -1
    s_waitcnt lgkmcnt(0)
    v_add_u32 v128, 8192, v128
    v_add_u32 v129, 8192, v129
    v_add_u32 v130, 8192, v130
    v_add_u32 v131, 8192, v131
    v_add_u32 v132, 1024, v132
    s_sub_u32 s40, s40, 1
    s_cmp_lg_u32 s40, 0
    s_cbranch_scc1 L_hw
    s_add_u32 s43, s43, 1
    v_mov_b32 v12, s43
    ds_write_b32 v6, v12 offset:4
    s_add_u32 s76, s76, 512
    s_addc_u32 s77, s77, 0
    s_cmp_lt_u32 s43, 2
    s_cbranch_scc1 L_hset
    s_mov_b32 s44, 30
    s_mov_b32 s35, 120
    v_readfirstlane_b32 s54, v139
    s_add_u32 s74, s74, s54
    s_addc_u32 s75, s75, 0
    s_mov_b32 s40, 0
    s_mov_b32 s84, 0
    s_bfe_u32 s42, s40, 65536
    s_lshl_b32 s42, s42, 8
    s_bfe_u32 s58, s40, 65537
    s_lshl_b32 s58, s58, 9
    s_or_b32 s42, s42, s58
    s_bfe_u32 s58, s40, 65538
    s_lshl_b32 s58, s58, 10
    s_or_b32 s42, s42, s58
    s_lshr_b32 s58, s40, 3
    s_add_u32 s58, s58, 6
    s_lshl_b32 s58, s58, 11
    s_or_b32 s42, s42, s58
    s_add_u32 s54, s42, 0
    buffer_load_dwordx4 v[48:51], v1, s[20:23], s54 offen
    s_add_u32 s54, s42, 131072
    buffer_load_dwordx4 v[52:55], v1, s[20:23], s54 offen
    s_add_u32 s54, s42, 262144
    buffer_load_dwordx4 v[56:59], v1, s[20:23], s54 offen
    s_add_u32 s54, s42, 393216
    buffer_load_dwordx4 v[60:63], v1, s[20:23], s54 offen
    s_add_u32 s54, s42, 524288
    buffer_load_dwordx4 v[64:67], v1, s[20:23], s54 offen
    s_add_u32 s54, s42, 655360
    buffer_load_dwordx4 v[68:71], v1, s[20:23], s54 offen
    s_add_u32 s54, s42, 786432
    buffer_load_dwordx4 v[72:75], v1, s[20:23], s54 offen
    s_add_u32 s54, s42, 917504
    buffer_load_dwordx4 v[76:79], v1, s[20:23], s54 offen
    s_add_u32 s54, s42, 128
    buffer_load_dwordx4 v[80:83], v1, s[20:23], s54 offen
    s_add_u32 s54, s42, 131200
    buffer_load_dwordx4 v[84:87], v1, s[20:23], s54 offen
    s_add_u32 s54, s42, 262272
    buffer_load_dwordx4 v[88:91], v1, s[20:23], s54 offen
    s_add_u32 s54, s42, 393344
    buffer_load_dwordx4 v[92:95], v1, s[20:23], s54 offen
    s_add_u32 s54, s42, 524416
    buffer_load_dwordx4 v[96:99], v1, s[20:23], s54 offen
    s_add_u32 s54, s42, 655488
    buffer_load_dwordx4 v[100:103], v1, s[20:23], s54 offen
    s_add_u32 s54, s42, 786560
    buffer_load_dwordx4 v[104:107], v1, s[20:23], s54 offen
    s_add_u32 s54, s42, 917632
    buffer_load_dwordx4 v[108:111], v1, s[20:23], s54 offen
    v_add_u32 v16, s84, v200
    v_add_u32 v18, s84, v202
    v_add_u32 v128, 0, v8
    v_add_u32 v129, 0, v9
    v_add_u32 v130, 0, v10
    v_add_u32 v131, 0, v11
    v_add_u32 v132, 8192, v7
L_pw:
    s_add_u32 s40, s40, 1
    s_cmp_ge_u32 s40, 16
    s_cselect_b32 s22, 0, s22
    s_bfe_u32 s42, s40, 65536
    s_lshl_b32 s42, s42, 8
    s_bfe_u32 s58, s40, 65537
    s_lshl_b32 s58, s58, 9
    s_or_b32 s42, s42, s58
    s_bfe_u32 s58, s40, 65538
    s_lshl_b32 s58, s58, 10
    s_or_b32 s42, s42, s58
    s_lshr_b32 s58, s40, 3
    s_add_u32 s58, s58, 6
    s_lshl_b32 s58, s58, 11
    s_or_b32 s42, s42, s58
    s_waitcnt vmcnt(8)
    s_mov_b64 exec, s[82:83]
    ds_write_b128 v16, v[48:51] offset:0
    ds_write_b128 v18, v[52:55] offset:1024
    ds_write_b128 v16, v[56:59] offset:2048
    ds_write_b128 v18, v[60:63] offset:3072
    ds_write_b128 v16, v[64:67] offset:4096
    ds_write_b128 v18, v[68:71] offset:5120
    ds_write_b128 v16, v[72:75] offset:6144
    ds_write_b128 v18, v[76:79] offset:7168
    s_mov_b64 exec, -1
    s_waitcnt lgkmcnt(0)
    s_add_u32 s54, s42, 0
    buffer_load_dwordx4 v[48:51], v1, s[20:23], s54 offen
    s_add_u32 s54, s42, 131072
    buffer_load_dwordx4 v[52:55], v1, s[20:23], s54 offen
    s_add_u32 s54, s42, 262144
    buffer_load_dwordx4 v[56:59], v1, s[20:23], s54 offen
    s_add_u32 s54, s42, 393216
    buffer_load_dwordx4 v[60:63], v1, s[20:23], s54 offen
    s_add_u32 s54, s42, 524288
    buffer_load_dwordx4 v[64:67], v1, s[20:23], s54 offen
    s_add_u32 s54, s42, 655360
    buffer_load_dwordx4 v[68:71], v1, s[20:23], s54 offen
    s_add_u32 s54, s42, 786432
    buffer_load_dwordx4 v[72:75], v1, s[20:23], s54 offen
    s_add_u32 s54, s42, 917504
    buffer_load_dwordx4 v[76:79], v1, s[20:23], s54 offen
    s_waitcnt vmcnt(8)
    s_mov_b64 exec, s[82:83]
    ds_write_b128 v18, v[80:83] offset:0
    ds_write_b128 v16, v[84:87] offset:1024
    ds_write_b128 v18, v[88:91] offset:2048
    ds_write_b128 v16, v[92:95] offset:3072
    ds_write_b128 v18, v[96:99] offset:4096
    ds_write_b128 v16, v[100:103] offset:5120
    ds_write_b128 v18, v[104:107] offset:6144
    ds_write_b128 v16, v[108:111] offset:7168
    s_mov_b64 exec, -1
    s_waitcnt lgkmcnt(0)
    s_add_u32 s54, s42, 128
    buffer_load_dwordx4 v[80:83], v1, s[20:23], s54 offen
    s_add_u32 s54, s42, 131200
    buffer_load_dwordx4 v[84:87], v1, s[20:23], s54 offen
    s_add_u32 s54, s42, 262272
    buffer_load_dwordx4 v[88:91], v1, s[20:23], s54 offen
    s_add_u32 s54, s42, 393344
    buffer_load_dwordx4 v[92:95], v1, s[20:23], s54 offen
    s_add_u32 s54, s42, 524416
    buffer_load_dwordx4 v[96:99], v1, s[20:23], s54 offen
    s_add_u32 s54, s42, 655488
    buffer_load_dwordx4 v[100:103], v1, s[20:23], s54 offen
    s_add_u32 s54, s42, 786560
    buffer_load_dwordx4 v[104:107], v1, s[20:23], s54 offen
    s_add_u32 s54, s42, 917632
    buffer_load_dwordx4 v[108:111], v1, s[20:23], s54 offen
    ds_read_b64_tr_b16 v[180:181], v128 offset:0
    ds_read_b64_tr_b16 v[182:183], v130 offset:0
    ds_read_b64_tr_b16 v[184:185], v128 offset:4096
    ds_read_b64_tr_b16 v[186:187], v130 offset:4096
    ds_read_b64_tr_b16 v[188:189], v128 offset:8
    ds_read_b64_tr_b16 v[190:191], v130 offset:8
    ds_read_b64_tr_b16 v[192:193], v128 offset:4104
    ds_read_b64_tr_b16 v[194:195], v130 offset:4104
    ds_read_b64_tr_b16 v[216:217], v129 offset:0
    ds_read_b64_tr_b16 v[218:219], v131 offset:0
    ds_read_b64_tr_b16 v[220:221], v129 offset:4096
    ds_read_b64_tr_b16 v[222:223], v131 offset:4096
    ds_read_b64_tr_b16 v[224:225], v129 offset:8
    ds_read_b64_tr_b16 v[226:227], v131 offset:8
    ds_read_b64_tr_b16 v[228:229], v129 offset:4104
    ds_read_b64_tr_b16 v[230:231], v131 offset:4104
    s_waitcnt lgkmcnt(12)
    v_mfma_f32_16x16x32_bf16 v[32:35], v[180:183], v[24:27], 0
    v_mfma_f32_16x16x32_bf16 v[32:35], v[184:187], v[28:31], v[32:35]
    s_waitcnt lgkmcnt(8)
    v_mfma_f32_16x16x32_bf16 v[36:39], v[188:191], v[24:27], 0
    v_mfma_f32_16x16x32_bf16 v[36:39], v[192:195], v[28:31], v[36:39]
    s_waitcnt lgkmcnt(4)
    v_mfma_f32_16x16x32_bf16 v[40:43], v[216:219], v[24:27], 0
    v_mfma_f32_16x16x32_bf16 v[40:43], v[220:223], v[28:31], v[40:43]
    s_waitcnt lgkmcnt(0)
    v_mfma_f32_16x16x32_bf16 v[44:47], v[224:227], v[24:27], 0
    v_mfma_f32_16x16x32_bf16 v[44:47], v[228:231], v[28:31], v[44:47]
    s_nop 7
    s_mov_b64 exec, s[60:61]
    ds_write2_b32 v132, v32, v36 offset0:0 offset1:1
    ds_write2_b32 v132, v40, v44 offset0:2 offset1:3
    ds_write2_b32 v132, v33, v37 offset0:16 offset1:17
    ds_write2_b32 v132, v41, v45 offset0:18 offset1:19
    ds_write2_b32 v132, v34, v38 offset0:32 offset1:33
    ds_write2_b32 v132, v42, v46 offset0:34 offset1:35
    ds_write2_b32 v132, v35, v39 offset0:48 offset1:49
    ds_write2_b32 v132, v43, v47 offset0:50 offset1:51
    s_mov_b64 exec, -1
    s_waitcnt lgkmcnt(0)
    v_add_u32 v132, 1024, v132
    s_cmp_lt_u32 s40, 16
    s_cbranch_scc1 L_pw
    s_waitcnt vmcnt(0)
    v_mov_b32 v12, 3
    ds_write_b32 v6, v12 offset:4
L_hp:
    s_sub_u32 s41, s35, 2
L_w18:
    ds_read_b128 v[12:15], v6 offset:16
    s_waitcnt lgkmcnt(0)
    v_min3_u32 v12, v12, v13, v14
    v_min_u32 v12, v12, v15
    s_nop 0
    v_readfirstlane_b32 s54, v12
    s_cmp_ge_u32 s54, s41
    s_cbranch_scc1 L_w18_ok
    s_sleep 1
    s_sub_u32 s72, s72, 1
    s_cbranch_scc1 L_end
    s_branch L_w18
L_w18_ok:
    s_mov_b32 s41, 1
    s_atomic_add s41, s[74:75], 0 glc
    s_waitcnt lgkmcnt(0)
    s_sub_u32 s55, s41, 8
    s_and_b32 s57, s55, 1
    s_lshl_b32 s57, s57, 9
    s_lshr_b32 s55, s55, 1
    s_add_u32 s55, s55, 8
    s_cmp_lt_u32 s41, 8
    s_cselect_b32 s55, s41, s55
    s_cselect_b32 s57, 1024, s57
    s_cselect_b32 s58, 4, 2
    s_add_u32 s35, s35, s58
    s_and_b32 s58, s55, 15
    s_lshl_b32 s58, s58, 12
    s_or_b32 s57, s57, s58
    s_bfe_u32 s42, s55, 65536
    s_lshl_b32 s42, s42, 3
    s_bfe_u32 s58, s55, 65537
    s_lshl_b32 s58, s58, 4
    s_or_b32 s42, s42, s58
    s_bfe_u32 s58, s55, 65538
    s_lshl_b32 s58, s58, 5
    s_or_b32 s42, s42, s58
    s_lshr_b32 s55, s55, 3
    s_add_u32 s55, s55, 6
    s_and_b32 s55, s55, 7
    s_lshl_b32 s55, s55, 6
    s_or_b32 s42, s42, s55
    s_lshl_b32 s55, s53, 1
    s_or_b32 s42, s42, s55
    s_cmp_ge_u32 s41, 24
    s_cselect_b32 s57, 2048, s57
    s_lshl_b32 s55, s44, 16
    s_or_b32 s55, s55, s42
    s_or_b32 s55, s55, s57
    s_and_b32 s56, s44, 3
    s_lshl_b32 s57, s56, 2
    v_add_u32 v13, s57, v6
    v_mov_b32 v12, s55
    ds_write_b32 v13, v12 offset:32
    s_cmp_ge_u32 s41, 24
    s_cbranch_scc1 L_hfin
    s_add_u32 s44, s44, 1
    s_branch L_hp
L_hfin:
    s_cmp_ge_u32 s32, 8
    s_cbranch_scc1 L_end
    v_and_b32 v137, 15, v0
    v_lshlrev_b32 v137, 4, v137
    v_bfe_u32 v138, v0, 4, 1
    v_lshl_add_u32 v137, v138, 3, v137
L_w19:
    ds_read_b128 v[12:15], v6 offset:16
    s_waitcnt lgkmcnt(0)
    v_min3_u32 v12, v12, v13, v14
    v_min_u32 v12, v12, v15
    s_nop 0
    v_readfirstlane_b32 s54, v12
    s_cmp_ge_u32 s54, 65535
    s_cbranch_scc1 L_w19_ok
    s_sleep 2
    s_sub_u32 s72, s72, 1
    s_cbranch_scc1 L_end
    s_branch L_w19
L_w19_ok:
    buffer_load_dwordx4 v[80:83], v3, s[28:31], 0 offen offset:0 sc1
    buffer_load_dwordx4 v[84:87], v3, s[28:31], 0 offen offset:1024 sc1
    buffer_load_dwordx4 v[88:91], v3, s[28:31], 0 offen offset:2048 sc1
    buffer_load_dwordx4 v[92:95], v3, s[28:31], 0 offen offset:3072 sc1
    buffer_load_dwordx4 v[96:99], v3, s[28:31], s78 offen offset:0 sc1
    buffer_load_dwordx4 v[100:103], v3, s[28:31], s78 offen offset:1024 sc1
    buffer_load_dwordx4 v[104:107], v3, s[28:31], s78 offen offset:2048 sc1
    buffer_load_dwordx4 v[108:111], v3, s[28:31], s78 offen offset:3072 sc1
    s_sleep 8
L_fpoll:
    buffer_load_dwordx4 v[48:51], v3, s[28:31], 0 offen offset:0 sc1
    buffer_load_dwordx4 v[52:55], v3, s[28:31], 0 offen offset:1024 sc1
    buffer_load_dwordx4 v[56:59], v3, s[28:31], 0 offen offset:2048 sc1
    buffer_load_dwordx4 v[60:63], v3, s[28:31], 0 offen offset:3072 sc1
    buffer_load_dwordx4 v[64:67], v3, s[28:31], s78 offen offset:0 sc1
    buffer_load_dwordx4 v[68:71], v3, s[28:31], s78 offen offset:1024 sc1
    buffer_load_dwordx4 v[72:75], v3, s[28:31], s78 offen offset:2048 sc1
    buffer_load_dwordx4 v[76:79], v3, s[28:31], s78 offen offset:3072 sc1
    s_waitcnt vmcnt(15)
    v_xor_b32 v12, v80, v140
    v_and_b32 v32, -2, v80
    v_bitop3_b32 v12, v12, v81, v141 bitop3:0x60
    v_and_b32 v33, -2, v81
    v_bitop3_b32 v12, v12, v82, v142 bitop3:0x60
    v_and_b32 v34, -2, v82
    v_bitop3_b32 v12, v12, v83, v143 bitop3:0x60
    v_and_b32 v35, -2, v83
    s_waitcnt vmcnt(14)
    v_bitop3_b32 v12, v12, v84, v144 bitop3:0x60
    v_and_b32 v84, -2, v84
    v_add_f32 v32, v32, v84
    v_bitop3_b32 v12, v12, v85, v145 bitop3:0x60
    v_and_b32 v85, -2, v85
    v_add_f32 v33, v33, v85
    v_bitop3_b32 v12, v12, v86, v146 bitop3:0x60
    v_and_b32 v86, -2, v86
    v_add_f32 v34, v34, v86
    v_bitop3_b32 v12, v12, v87, v147 bitop3:0x60
    v_and_b32 v87, -2, v87
    v_add_f32 v35, v35, v87
    s_waitcnt vmcnt(13)
    v_bitop3_b32 v12, v12, v88, v148 bitop3:0x60
    v_and_b32 v88, -2, v88
    v_add_f32 v32, v32, v88
    v_bitop3_b32 v12, v12, v89, v149 bitop3:0x60
    v_and_b32 v89, -2, v89
    v_add_f32 v33, v33, v89
    v_bitop3_b32 v12, v12, v90, v150 bitop3:0x60
    v_and_b32 v90, -2, v90
    v_add_f32 v34, v34, v90
    v_bitop3_b32 v12, v12, v91, v151 bitop3:0x60
    v_and_b32 v91, -2, v91
    v_add_f32 v35, v35, v91
    s_waitcnt vmcnt(12)
    v_bitop3_b32 v12, v12, v92, v152 bitop3:0x60
    v_and_b32 v92, -2, v92
    v_add_f32 v32, v32, v92
    v_bitop3_b32 v12, v12, v93, v153 bitop3:0x60
    v_and_b32 v93, -2, v93
    v_add_f32 v33, v33, v93
    v_bitop3_b32 v12, v12, v94, v154 bitop3:0x60
    v_and_b32 v94, -2, v94
    v_add_f32 v34, v34, v94
    v_bitop3_b32 v12, v12, v95, v155 bitop3:0x60
    v_and_b32 v95, -2, v95
    v_add_f32 v35, v35, v95
    s_waitcnt vmcnt(11)
    v_bitop3_b32 v12, v12, v96, v156 bitop3:0x60
    v_and_b32 v96, -2, v96
    v_add_f32 v32, v32, v96
    v_bitop3_b32 v12, v12, v97, v157 bitop3:0x60
    v_and_b32 v97, -2, v97
    v_add_f32 v33, v33, v97
    v_bitop3_b32 v12, v12, v98, v158 bitop3:0x60
    v_and_b32 v98, -2, v98
    v_add_f32 v34, v34, v98
    v_bitop3_b32 v12, v12, v99, v159 bitop3:0x60
    v_and_b32 v99, -2, v99
    v_add_f32 v35, v35, v99
    s_waitcnt vmcnt(10)
    v_bitop3_b32 v12, v12, v100, v160 bitop3:0x60
    v_and_b32 v100, -2, v100
    v_add_f32 v32, v32, v100
    v_bitop3_b32 v12, v12, v101, v161 bitop3:0x60
    v_and_b32 v101, -2, v101
    v_add_f32 v33, v33, v101
    v_bitop3_b32 v12, v12, v102, v162 bitop3:0x60
    v_and_b32 v102, -2, v102
    v_add_f32 v34, v34, v102
    v_bitop3_b32 v12, v12, v103, v163 bitop3:0x60
    v_and_b32 v103, -2, v103
    v_add_f32 v35, v35, v103
    s_waitcnt vmcnt(9)
    v_bitop3_b32 v12, v12, v104, v164 bitop3:0x60
    v_and_b32 v104, -2, v104
    v_add_f32 v32, v32, v104
    v_bitop3_b32 v12, v12, v105, v165 bitop3:0x60
    v_and_b32 v105, -2, v105
    v_add_f32 v33, v33, v105
    v_bitop3_b32 v12, v12, v106, v166 bitop3:0x60
    v_and_b32 v106, -2, v106
    v_add_f32 v34, v34, v106
    v_bitop3_b32 v12, v12, v107, v167 bitop3:0x60
    v_and_b32 v107, -2, v107
    v_add_f32 v35, v35, v107
    s_waitcnt vmcnt(8)
    v_bitop3_b32 v12, v12, v108, v168 bitop3:0x60
    v_and_b32 v108, -2, v108
    v_add_f32 v32, v32, v108
    v_bitop3_b32 v12, v12, v109, v169 bitop3:0x60
    v_and_b32 v109, -2, v109
    v_add_f32 v33, v33, v109
    v_bitop3_b32 v12, v12, v110, v170 bitop3:0x60
    v_and_b32 v110, -2, v110
    v_add_f32 v34, v34, v110
    v_bitop3_b32 v12, v12, v111, v171 bitop3:0x60
    v_and_b32 v111, -2, v111
    v_add_f32 v35, v35, v111
    v_and_b32 v12, 1, v12
    v_cmp_eq_u32 vcc, 0, v12
    s_nop 4
    s_cbranch_vccz L_fgot
    buffer_load_dwordx4 v[80:83], v3, s[28:31], 0 offen offset:0 sc1
    buffer_load_dwordx4 v[84:87], v3, s[28:31], 0 offen offset:1024 sc1
    buffer_load_dwordx4 v[88:91], v3, s[28:31], 0 offen offset:2048 sc1
    buffer_load_dwordx4 v[92:95], v3, s[28:31], 0 offen offset:3072 sc1
    buffer_load_dwordx4 v[96:99], v3, s[28:31], s78 offen offset:0 sc1
    buffer_load_dwordx4 v[100:103], v3, s[28:31], s78 offen offset:1024 sc1
    buffer_load_dwordx4 v[104:107], v3, s[28:31], s78 offen offset:2048 sc1
    buffer_load_dwordx4 v[108:111], v3, s[28:31], s78 offen offset:3072 sc1
    s_waitcnt vmcnt(15)
    v_xor_b32 v12, v48, v140
    v_and_b32 v32, -2, v48
    v_bitop3_b32 v12, v12, v49, v141 bitop3:0x60
    v_and_b32 v33, -2, v49
    v_bitop3_b32 v12, v12, v50, v142 bitop3:0x60
    v_and_b32 v34, -2, v50
    v_bitop3_b32 v12, v12, v51, v143 bitop3:0x60
    v_and_b32 v35, -2, v51
    s_waitcnt vmcnt(14)
    v_bitop3_b32 v12, v12, v52, v144 bitop3:0x60
    v_and_b32 v52, -2, v52
    v_add_f32 v32, v32, v52
    v_bitop3_b32 v12, v12, v53, v145 bitop3:0x60
    v_and_b32 v53, -2, v53
    v_add_f32 v33, v33, v53
    v_bitop3_b32 v12, v12, v54, v146 bitop3:0x60
    v_and_b32 v54, -2, v54
    v_add_f32 v34, v34, v54
    v_bitop3_b32 v12, v12, v55, v147 bitop3:0x60
    v_and_b32 v55, -2, v55
    v_add_f32 v35, v35, v55
    s_waitcnt vmcnt(13)
    v_bitop3_b32 v12, v12, v56, v148 bitop3:0x60
    v_and_b32 v56, -2, v56
    v_add_f32 v32, v32, v56
    v_bitop3_b32 v12, v12, v57, v149 bitop3:0x60
    v_and_b32 v57, -2, v57
    v_add_f32 v33, v33, v57
    v_bitop3_b32 v12, v12, v58, v150 bitop3:0x60
    v_and_b32 v58, -2, v58
    v_add_f32 v34, v34, v58
    v_bitop3_b32 v12, v12, v59, v151 bitop3:0x60
    v_and_b32 v59, -2, v59
    v_add_f32 v35, v35, v59
    s_waitcnt vmcnt(12)
    v_bitop3_b32 v12, v12, v60, v152 bitop3:0x60
    v_and_b32 v60, -2, v60
    v_add_f32 v32, v32, v60
    v_bitop3_b32 v12, v12, v61, v153 bitop3:0x60
    v_and_b32 v61, -2, v61
    v_add_f32 v33, v33, v61
    v_bitop3_b32 v12, v12, v62, v154 bitop3:0x60
    v_and_b32 v62, -2, v62
    v_add_f32 v34, v34, v62
    v_bitop3_b32 v12, v12, v63, v155 bitop3:0x60
    v_and_b32 v63, -2, v63
    v_add_f32 v35, v35, v63
    s_waitcnt vmcnt(11)
    v_bitop3_b32 v12, v12, v64, v156 bitop3:0x60
    v_and_b32 v64, -2, v64
    v_add_f32 v32, v32, v64
    v_bitop3_b32 v12, v12, v65, v157 bitop3:0x60
    v_and_b32 v65, -2, v65
    v_add_f32 v33, v33, v65
    v_bitop3_b32 v12, v12, v66, v158 bitop3:0x60
    v_and_b32 v66, -2, v66
    v_add_f32 v34, v34, v66
    v_bitop3_b32 v12, v12, v67, v159 bitop3:0x60
    v_and_b32 v67, -2, v67
    v_add_f32 v35, v35, v67
    s_waitcnt vmcnt(10)
    v_bitop3_b32 v12, v12, v68, v160 bitop3:0x60
    v_and_b32 v68, -2, v68
    v_add_f32 v32, v32, v68
    v_bitop3_b32 v12, v12, v69, v161 bitop3:0x60
    v_and_b32 v69, -2, v69
    v_add_f32 v33, v33, v69
    v_bitop3_b32 v12, v12, v70, v162 bitop3:0x60
    v_and_b32 v70, -2, v70
    v_add_f32 v34, v34, v70
    v_bitop3_b32 v12, v12, v71, v163 bitop3:0x60
    v_and_b32 v71, -2, v71
    v_add_f32 v35, v35, v71
    s_waitcnt vmcnt(9)
    v_bitop3_b32 v12, v12, v72, v164 bitop3:0x60
    v_and_b32 v72, -2, v72
    v_add_f32 v32, v32, v72
    v_bitop3_b32 v12, v12, v73, v165 bitop3:0x60
    v_and_b32 v73, -2, v73
    v_add_f32 v33, v33, v73
    v_bitop3_b32 v12, v12, v74, v166 bitop3:0x60
    v_and_b32 v74, -2, v74
    v_add_f32 v34, v34, v74
    v_bitop3_b32 v12, v12, v75, v167 bitop3:0x60
    v_and_b32 v75, -2, v75
    v_add_f32 v35, v35, v75
    s_waitcnt vmcnt(8)
    v_bitop3_b32 v12, v12, v76, v168 bitop3:0x60
    v_and_b32 v76, -2, v76
    v_add_f32 v32, v32, v76
    v_bitop3_b32 v12, v12, v77, v169 bitop3:0x60
    v_and_b32 v77, -2, v77
    v_add_f32 v33, v33, v77
    v_bitop3_b32 v12, v12, v78, v170 bitop3:0x60
    v_and_b32 v78, -2, v78
    v_add_f32 v34, v34, v78
    v_bitop3_b32 v12, v12, v79, v171 bitop3:0x60
    v_and_b32 v79, -2, v79
    v_add_f32 v35, v35, v79
    v_and_b32 v12, 1, v12
    v_cmp_eq_u32 vcc, 0, v12
    s_nop 4
    s_cbranch_vccz L_fgot
    s_sub_u32 s72, s72, 1
    s_cbranch_scc1 L_end
    s_branch L_fpoll
L_fgot:
    v_mov_b32 v36, v32
    v_mov_b32 v37, v33
    v_mov_b32 v38, v34
    v_mov_b32 v39, v35
    s_nop 1
    v_permlane32_swap_b32 v32, v36
    v_permlane32_swap_b32 v33, v37
    v_permlane32_swap_b32 v34, v38
    v_permlane32_swap_b32 v35, v39
    v_add_f32 v32, v32, v36
    v_add_f32 v33, v33, v37
    v_add_f32 v34, v34, v38
    v_add_f32 v35, v35, v39
    v_cvt_pk_bf16_f32 v12, v32, v33
    v_cvt_pk_bf16_f32 v13, v34, v35
    s_mov_b32 exec_hi, 0
    global_store_dwordx2 v137, v[12:13], s[14:15]
L_end:
    s_endpgm
L_codeend:
.section .rodata,"a"
.p2align 6
.amdhsa_kernel standalone__low_rank_proj_linformer__decode_kernel
  .amdhsa_next_free_vgpr 232
  .amdhsa_next_free_sgpr 100
  .amdhsa_accum_offset 232
  .amdhsa_group_segment_fixed_size 0
  .amdhsa_kernarg_size 64
  .amdhsa_user_sgpr_count 2
  .amdhsa_user_sgpr_kernarg_segment_ptr 1
  .amdhsa_system_sgpr_workgroup_id_x 1
.end_amdhsa_kernel
```
